```python
import torch

def _softmax(x, axis=-1):
    return torch.softmax(x, dim=axis)
def _gelu(x):
    return torch.nn.functional.gelu(x, approximate="tanh")
def _silu(x):
    return torch.nn.functional.silu(x)
def _sigmoid(x):
    return torch.sigmoid(x)
def _layernorm(x, axis=-1, eps=1e-5):
    m = x.mean(dim=axis, keepdim=True)
    v = x.var(dim=axis, keepdim=True, unbiased=False)
    return (x - m) / torch.sqrt(v + eps)
def _scatter_add(tgt, idx, src, axis=0):
    return tgt.clone().index_add_(axis, idx, src)
def _segment_sum(src, seg, n):
    out = torch.zeros((n,) + src.shape[1:], dtype=src.dtype)
    return out.index_add_(0, seg, src)
def _pad(x, pw):
    flat = tuple(v for pair in reversed(pw) for v in pair)
    return torch.nn.functional.pad(x, flat)

kernel_name = 'gated_mix__ssm_conv_s5__dense_activation_silu__prompt'

def setup_inputs():

    _w = (lambda a: (lambda t: t.to(torch.bfloat16) if t.is_floating_point() else t)(torch.as_tensor(a)))
    def _A_setup():
        B, S, D = 1, 2048, 512
        P = D
        Lambda_re = -0.5 * (lambda _x: torch.exp(torch.as_tensor(_x)))((lambda *s: torch.randn(*s, dtype=torch.bfloat16) * 0.2)(P))
        Lambda_im = (lambda *s: torch.randn(*s, dtype=torch.bfloat16) * 0.4)(P) * 1.0
        B_re = (lambda *s: torch.randn(*s, dtype=torch.bfloat16) * 0.2)(P, D) * (D ** -0.5)
        B_im = (lambda *s: torch.randn(*s, dtype=torch.bfloat16) * 0.2)(P, D) * (D ** -0.5)
        C_re = (lambda *s: torch.randn(*s, dtype=torch.bfloat16) * 0.2)(D, P) * (P ** -0.5)
        C_im = (lambda *s: torch.randn(*s, dtype=torch.bfloat16) * 0.2)(D, P) * (P ** -0.5)
        log_dt = (lambda *s: torch.randn(*s, dtype=torch.bfloat16) * 0.2)(P) * 0.3 - 2.0
        Dskip = (lambda *s: torch.randn(*s, dtype=torch.bfloat16) * 0.05)(D)
        return {
            "x": _w((lambda *s: torch.randn(*s, dtype=torch.bfloat16) * 0.05)(B, S, D)),
            "Lambda_re": _w(Lambda_re),
            "Lambda_im": _w(Lambda_im),
            "B_re": _w(B_re),
            "B_im": _w(B_im),
            "C_re": _w(C_re),
            "C_im": _w(C_im),
            "log_dt": _w(log_dt),
            "Dskip": _w(Dskip),
        }
    _A_in = _A_setup()

    def _B_setup():
        B, S, D, F = 1, 2048, 512, 1792
        return {
            "x": _w((lambda *s: torch.randn(*s, dtype=torch.bfloat16) * 0.05)(B, S, D)),
            "w1": _w((lambda *s: torch.randn(*s, dtype=torch.bfloat16) * 3.2)(D, F) * (D ** -0.5)),
            "w2": _w((lambda *s: torch.randn(*s, dtype=torch.bfloat16) * 0.1)(F, D) * (F ** -0.5)),
        }
    _B_in = _B_setup()

    return {
        "A_x": _A_in["x"],
        "A_Lambda_re": _A_in["Lambda_re"],
        "A_Lambda_im": _A_in["Lambda_im"],
        "A_B_re": _A_in["B_re"],
        "A_B_im": _A_in["B_im"],
        "A_C_re": _A_in["C_re"],
        "A_C_im": _A_in["C_im"],
        "A_log_dt": _A_in["log_dt"],
        "A_Dskip": _A_in["Dskip"],
        "B_x": _B_in["x"],
        "B_w1": _B_in["w1"],
        "B_w2": _B_in["w2"],
        "gate_w": _w((lambda *s: torch.randn(*s, dtype=torch.bfloat16) * 0.05)(512) * 16.0),
    }

def reference(A_x, A_Lambda_re, A_Lambda_im, A_B_re, A_B_im, A_C_re, A_C_im, A_log_dt, A_Dskip, B_x, B_w1, B_w2, gate_w):
    def _A_ref(x, Lambda_re, Lambda_im, B_re, B_im, C_re, C_im, log_dt, Dskip):
        Bsz, L, H = x.shape
        Lam = Lambda_re + 1j * Lambda_im
        Bmat = B_re + 1j * B_im
        Cmat = C_re + 1j * C_im
        dt = torch.exp(log_dt)
        Lam_bar = torch.exp(dt * Lam)
        B_bar = ((Lam_bar - 1.0) / Lam)[:, None] * Bmat
        Bu = torch.einsum("bld,pd->blp", x + 0j, B_bar)
        h = torch.zeros_like(Bu[:, 0, :])
        hs = []
        for t in range(L):
            h = Lam_bar[None, :] * h + Bu[:, t, :]
            hs.append(h)
        hseq = torch.stack(hs, 1)
        y = 2.0 * torch.einsum("blp,dp->bld", hseq, Cmat).real + x * Dskip[None, None, :]
        return y

    def _B_ref(x, w1, w2):
        h = torch.einsum("bsd,df->bsf", x, w1)
        h = _silu(h)
        out = torch.einsum("bsf,fd->bsd", h, w2)
        return out

    x = A_x
    g = _sigmoid((x * gate_w).sum(-1, keepdims=True))
    a = _A_ref(x, A_Lambda_re, A_Lambda_im, A_B_re, A_B_im, A_C_re, A_C_im, A_log_dt, A_Dskip)
    b = _B_ref(x, B_w1, B_w2)
    return g * a + (1 - g) * b
```

```asm
; @launch grid=(256,1,1) block=(512,1,1) lds=163840
.amdgcn_target "amdgcn-amd-amdhsa--gfx950"
.text
.globl gated_mix__ssm_conv_s5__dense_activation_silu__prompt_kernel
.p2align 8
.type gated_mix__ssm_conv_s5__dense_activation_silu__prompt_kernel,@function
gated_mix__ssm_conv_s5__dense_activation_silu__prompt_kernel:
  s_getpc_b64 s[40:41]
L_k1_pc:
  s_sub_u32 s40, s40, L_k1_pc-gated_mix__ssm_conv_s5__dense_activation_silu__prompt_kernel
  s_subb_u32 s41, s41, 0
  s_lshr_b32 s42, s2, 3
  s_lshl_b32 s42, s42, 10
  v_lshrrev_b32 v2, 6, v0
  v_lshlrev_b32 v2, 7, v2
  v_add_u32 v2, s42, v2
  v_min_u32 v2, L_code_end-gated_mix__ssm_conv_s5__dense_activation_silu__prompt_kernel-4, v2
  global_load_dword v14, v2, s[40:41]
  s_load_dwordx16 s[4:19], s[0:1], 0
  s_load_dwordx16 s[20:35], s[0:1], 64
  s_cmp_ge_u32 s2, 256
  s_cbranch_scc1 L_k1_end
  v_lshrrev_b32 v2, 6, v0
  v_and_b32 v1, 63, v0
  v_readfirstlane_b32 s60, v2
  s_and_b32 s68, s2, 7
  s_lshr_b32 s69, s2, 3
  s_and_b32 s70, s69, 3
  s_lshr_b32 s71, s69, 2
  s_lshr_b32 s62, s68, 1
  s_lshl_b32 s62, s62, 2
  s_add_u32 s62, s62, s70
  s_and_b32 s63, s68, 1
  s_lshl_b32 s63, s63, 3
  s_add_u32 s63, s63, s71
  s_lshl_b32 s56, s70, 1
  s_add_u32 s56, s56, s71
  s_and_b32 s56, s56, 3
  s_lshl_b32 s56, s56, 1
  s_and_b32 s61, s60, 3
  s_lshl_b32 s64, s61, 12
  s_lshl_b32 s65, s61, 11
  s_lshl_b32 s86, s62, 2
  s_add_u32 s86, s86, s61
  s_mul_i32 s86, s86, 180224
  s_cmp_ge_u32 s60, 4
  s_cbranch_scc1 L_k1_F
  s_waitcnt lgkmcnt(0)
  s_mov_b32 s52, s34
  s_mov_b32 s53, s35
  s_mov_b32 s54, 19022080
  s_mov_b32 s55, 0x20000
  v_and_b32 v48, 31, v1
  s_lshl_b32 s68, s63, 5
  v_add_u32 v48, s68, v48
  v_lshlrev_b32 v48, 1, v48
  global_load_ushort v56, v48, s[6:7]
  global_load_ushort v57, v48, s[8:9]
  global_load_ushort v58, v48, s[18:19]
  v_mov_b32 v48, 14565376
  global_load_dwordx2 v[122:123], v48, s[34:35] sc1
  s_mul_i32 s68, s62, 1024
  s_add_u32 s68, s68, 14565632
  v_mov_b32 v48, s68
  global_load_dword v106, v48, s[34:35] sc1
  s_lshl_b32 s68, s62, 10
  s_add_u32 s68, s68, 14417920
  v_and_b32 v48, 7, v1
  v_lshlrev_b32 v48, 7, v48
  v_add_u32 v48, s68, v48
  global_load_dword v107, v48, s[34:35] sc1
  s_cmp_eq_u32 s61, 2
  s_cbranch_scc0 L_k1_tlb_done
  v_mov_b32 v48, 0
  global_load_dword v108, v48, s[24:25]
  global_load_dword v109, v48, s[14:15]
  global_load_dword v110, v48, s[16:17]
  global_load_dword v111, v48, s[26:27]
  global_load_dword v112, v48, s[20:21]
  v_min_u32 v48, 19, v1
  v_lshlrev_b32 v48, 20, v48
  global_load_dword v113, v48, s[34:35] sc1
  v_and_b32 v48, 3, v1
  v_lshlrev_b32 v48, 20, v48
  global_load_dword v114, v48, s[30:31]
L_k1_tlb_done:
  v_and_b32 v48, 31, v1
  v_lshrrev_b32 v49, 5, v1
  v_bfe_u32 v50, v1, 1, 3
  v_xor_b32 v50, v49, v50
  v_lshlrev_b32 v49, 7, v48
  v_add_u32 v49, s64, v49
  v_lshrrev_b32 v51, 3, v48
  v_lshlrev_b32 v51, 11, v51
  v_and_b32 v48, 7, v48
  v_lshl_add_u32 v48, v48, 7, v51
  v_add_u32 v48, 16384, v48
  v_xor_b32 v51, 0, v50
  v_lshl_add_u32 v2, v51, 4, v49
  v_lshl_add_u32 v6, v51, 4, v48
  v_xor_b32 v51, 2, v50
  v_lshl_add_u32 v3, v51, 4, v49
  v_lshl_add_u32 v7, v51, 4, v48
  v_xor_b32 v51, 4, v50
  v_lshl_add_u32 v4, v51, 4, v49
  v_lshl_add_u32 v8, v51, 4, v48
  v_xor_b32 v51, 6, v50
  v_lshl_add_u32 v5, v51, 4, v49
  v_lshl_add_u32 v9, v51, 4, v48
  s_setprio 2
  s_waitcnt lgkmcnt(0)
  s_barrier
  ds_read_b128 a[0:3], v2 offset:0
  ds_read_b128 a[4:7], v3 offset:0
  ds_read_b128 a[8:11], v4 offset:0
  ds_read_b128 a[12:15], v5 offset:0
  ds_read_b128 a[16:19], v6 offset:0
  ds_read_b128 a[20:23], v6 offset:1024
  ds_read_b128 a[24:27], v7 offset:0
  ds_read_b128 a[28:31], v7 offset:1024
  ds_read_b128 a[32:35], v8 offset:0
  ds_read_b128 a[36:39], v8 offset:1024
  ds_read_b128 a[40:43], v9 offset:0
  ds_read_b128 a[44:47], v9 offset:1024
  s_waitcnt lgkmcnt(7)
  v_mfma_f32_32x32x16_bf16 v[64:79], a[0:3], a[16:19], 0
  s_waitcnt vmcnt(0)
  v_add_u32 v122, 1, v122
  v_or_b32 v123, 1, v123
  v_mov_b32 v124, 14565376
  v_mov_b32 v125, 0
  s_or_b32 s98, s2, s61
  s_cmp_lg_u32 s98, 0
  s_cbranch_scc1 L_k1_nononce
  global_store_dwordx2 v124, v[122:123], s[34:35] sc0 sc1
  global_store_dwordx2 v125, v[122:123], s[32:33] sc0 sc1
L_k1_nononce:
  s_waitcnt lgkmcnt(6)
  v_mfma_f32_32x32x16_bf16 v[80:95], a[0:3], a[20:23], 0
  v_lshlrev_b32 v56, 16, v56
  s_waitcnt lgkmcnt(5)
  v_mfma_f32_32x32x16_bf16 v[64:79], a[4:7], a[24:27], v[64:79]
  v_lshlrev_b32 v57, 16, v57
  v_lshlrev_b32 v58, 16, v58
  v_mul_f32 v58, 0x3fb8aa3b, v58
  v_exp_f32 v58, v58
  s_nop 0
  v_cvt_pk_bf16_f32 v58, v58, v58
  s_waitcnt lgkmcnt(4)
  v_mfma_f32_32x32x16_bf16 v[80:95], a[4:7], a[28:31], v[80:95]
  v_lshlrev_b32 v58, 16, v58
  v_mul_f32 v48, v58, v56
  v_mul_f32 v49, v58, v57
  v_mul_f32 v48, 0x3fb8aa3b, v48
  v_mul_f32 v49, 0x3e22f983, v49
  s_waitcnt lgkmcnt(3)
  v_mfma_f32_32x32x16_bf16 v[64:79], a[8:11], a[32:35], v[64:79]
  v_mul_f32 v50, 1.0, v48
  v_mul_f32 v51, 1.0, v49
  v_exp_f32 v50, v50
  v_rndne_f32 v52, v51
  v_sub_f32 v51, v51, v52
  s_waitcnt lgkmcnt(2)
  v_mfma_f32_32x32x16_bf16 v[80:95], a[8:11], a[36:39], v[80:95]
  v_cos_f32 v16, v51
  v_sin_f32 v17, v51
  v_mul_f32 v16, v50, v16
  v_mul_f32 v17, v50, v17
  v_mov_b32 v53, 0x41800000
  s_waitcnt lgkmcnt(1)
  v_mfma_f32_32x32x16_bf16 v[64:79], a[12:15], a[40:43], v[64:79]
  v_mul_f32 v50, v53, v48
  v_mul_f32 v51, v53, v49
  v_exp_f32 v50, v50
  v_rndne_f32 v52, v51
  v_sub_f32 v51, v51, v52
  s_waitcnt lgkmcnt(0)
  v_mfma_f32_32x32x16_bf16 v[80:95], a[12:15], a[44:47], v[80:95]
  v_cos_f32 v20, v51
  v_sin_f32 v21, v51
  v_mul_f32 v20, v50, v20
  v_mul_f32 v21, v50, v21
  v_mov_b32 v53, 0x42000000
  s_waitcnt lgkmcnt(0)
  s_barrier
  ds_read_b128 a[0:3], v2 offset:24576
  ds_read_b128 a[4:7], v3 offset:24576
  ds_read_b128 a[8:11], v4 offset:24576
  ds_read_b128 a[12:15], v5 offset:24576
  ds_read_b128 a[16:19], v6 offset:24576
  ds_read_b128 a[20:23], v6 offset:25600
  ds_read_b128 a[24:27], v7 offset:24576
  ds_read_b128 a[28:31], v7 offset:25600
  ds_read_b128 a[32:35], v8 offset:24576
  ds_read_b128 a[36:39], v8 offset:25600
  ds_read_b128 a[40:43], v9 offset:24576
  ds_read_b128 a[44:47], v9 offset:25600
  s_waitcnt lgkmcnt(7)
  v_mfma_f32_32x32x16_bf16 v[64:79], a[0:3], a[16:19], v[64:79]
  v_mul_f32 v50, v53, v48
  v_mul_f32 v51, v53, v49
  v_exp_f32 v50, v50
  v_rndne_f32 v52, v51
  v_sub_f32 v51, v51, v52
  s_waitcnt lgkmcnt(6)
  v_mfma_f32_32x32x16_bf16 v[80:95], a[0:3], a[20:23], v[80:95]
  v_cos_f32 v22, v51
  v_sin_f32 v23, v51
  v_mul_f32 v22, v50, v22
  v_mul_f32 v23, v50, v23
  v_mov_b32 v53, 0x43000000
  s_waitcnt lgkmcnt(5)
  v_mfma_f32_32x32x16_bf16 v[64:79], a[4:7], a[24:27], v[64:79]
  v_mul_f32 v50, v53, v48
  v_mul_f32 v51, v53, v49
  v_exp_f32 v50, v50
  v_rndne_f32 v52, v51
  v_sub_f32 v51, v51, v52
  s_waitcnt lgkmcnt(4)
  v_mfma_f32_32x32x16_bf16 v[80:95], a[4:7], a[28:31], v[80:95]
  v_cos_f32 v24, v51
  v_sin_f32 v25, v51
  v_mul_f32 v24, v50, v24
  v_mul_f32 v25, v50, v25
  v_mov_b32 v53, 0x43800000
  s_waitcnt lgkmcnt(3)
  v_mfma_f32_32x32x16_bf16 v[64:79], a[8:11], a[32:35], v[64:79]
  v_mul_f32 v50, v53, v48
  v_mul_f32 v51, v53, v49
  v_exp_f32 v50, v50
  v_rndne_f32 v52, v51
  v_sub_f32 v51, v51, v52
  s_waitcnt lgkmcnt(2)
  v_mfma_f32_32x32x16_bf16 v[80:95], a[8:11], a[36:39], v[80:95]
  v_cos_f32 v26, v51
  v_sin_f32 v27, v51
  v_mul_f32 v26, v50, v26
  v_mul_f32 v27, v50, v27
  v_lshrrev_b32 v53, 5, v1
  s_waitcnt lgkmcnt(1)
  v_mfma_f32_32x32x16_bf16 v[64:79], a[12:15], a[40:43], v[64:79]
  v_cvt_f32_u32 v32, v53
  v_lshlrev_b32 v53, 4, v53
  v_cvt_f32_u32 v53, v53
  v_mul_f32 v50, v53, v48
  v_mul_f32 v51, v53, v49
  s_waitcnt lgkmcnt(0)
  v_mfma_f32_32x32x16_bf16 v[80:95], a[12:15], a[44:47], v[80:95]
  v_exp_f32 v50, v50
  v_rndne_f32 v52, v51
  v_sub_f32 v51, v51, v52
  v_cos_f32 v28, v51
  v_sin_f32 v29, v51
  s_waitcnt lgkmcnt(0)
  s_barrier
  ds_read_b128 a[0:3], v2 offset:49152
  ds_read_b128 a[4:7], v3 offset:49152
  ds_read_b128 a[8:11], v4 offset:49152
  ds_read_b128 a[12:15], v5 offset:49152
  ds_read_b128 a[16:19], v6 offset:49152
  ds_read_b128 a[20:23], v6 offset:50176
  ds_read_b128 a[24:27], v7 offset:49152
  ds_read_b128 a[28:31], v7 offset:50176
  ds_read_b128 a[32:35], v8 offset:49152
  ds_read_b128 a[36:39], v8 offset:50176
  ds_read_b128 a[40:43], v9 offset:49152
  ds_read_b128 a[44:47], v9 offset:50176
  s_waitcnt lgkmcnt(7)
  v_mfma_f32_32x32x16_bf16 v[64:79], a[0:3], a[16:19], v[64:79]
  v_mul_f32 v28, v50, v28
  v_mul_f32 v29, v50, v29
  v_lshrrev_b32 v53, 5, v1
  v_lshlrev_b32 v53, 4, v53
  s_lshl_b32 s98, s61, 5
  s_waitcnt lgkmcnt(6)
  v_mfma_f32_32x32x16_bf16 v[80:95], a[0:3], a[20:23], v[80:95]
  v_add_u32 v53, s98, v53
  v_cvt_f32_u32 v53, v53
  v_mul_f32 v50, v53, v48
  v_mul_f32 v51, v53, v49
  v_exp_f32 v50, v50
  s_waitcnt lgkmcnt(5)
  v_mfma_f32_32x32x16_bf16 v[64:79], a[4:7], a[24:27], v[64:79]
  v_rndne_f32 v52, v51
  v_sub_f32 v51, v51, v52
  v_cos_f32 v30, v51
  v_sin_f32 v31, v51
  v_mul_f32 v30, v50, v30
  s_waitcnt lgkmcnt(4)
  v_mfma_f32_32x32x16_bf16 v[80:95], a[4:7], a[28:31], v[80:95]
  v_mul_f32 v31, v50, v31
  v_add_f32 v50, -1.0, v16
  v_mul_f32 v51, v56, v56
  v_fma_f32 v51, v57, v57, v51
  v_rcp_f32 v51, v51
  s_waitcnt lgkmcnt(3)
  v_mfma_f32_32x32x16_bf16 v[64:79], a[8:11], a[32:35], v[64:79]
  v_mul_f32 v18, v50, v56
  v_fma_f32 v18, v17, v57, v18
  v_mul_f32 v19, v17, v56
  v_fma_f32 v19, -v50, v57, v19
  v_add_f32 v51, v51, v51
  s_waitcnt lgkmcnt(2)
  v_mfma_f32_32x32x16_bf16 v[80:95], a[8:11], a[36:39], v[80:95]
  v_mul_f32 v18, v18, v51
  v_mul_f32 v19, v19, v51
  s_cmp_ge_u32 s61, 1
  s_cselect_b64 s[80:81], -1, 0
  s_cmp_ge_u32 s61, 2
  s_cselect_b64 s[82:83], -1, 0
  s_waitcnt lgkmcnt(1)
  v_mfma_f32_32x32x16_bf16 v[64:79], a[12:15], a[40:43], v[64:79]
  s_cmp_ge_u32 s61, 3
  s_cselect_b64 s[84:85], -1, 0
  v_lshlrev_b32 v13, 4, v1
  v_and_b32 v60, 31, v1
  s_waitcnt lgkmcnt(0)
  v_mfma_f32_32x32x16_bf16 v[80:95], a[12:15], a[44:47], v[80:95]
  v_lshlrev_b32 v60, 4, v60
  s_lshl_b32 s87, s63, 9
  s_add_u32 s87, s87, 14434304
  v_add_u32 v10, s87, v60
  v_and_b32 v60, 31, v1
  s_waitcnt lgkmcnt(0)
  s_barrier
  v_add_u32 v44, 0x10000, v2
  v_add_u32 v45, 0x10000, v3
  v_add_u32 v46, 0x10000, v4
  v_add_u32 v47, 0x10000, v5
  ds_read_b128 a[0:3], v44 offset:8192
  ds_read_b128 a[4:7], v45 offset:8192
  ds_read_b128 a[8:11], v46 offset:8192
  ds_read_b128 a[12:15], v47 offset:8192
  v_add_u32 v44, 0x10000, v6
  v_add_u32 v45, 0x10000, v7
  v_add_u32 v46, 0x10000, v8
  v_add_u32 v47, 0x10000, v9
  ds_read_b128 a[16:19], v44 offset:8192
  ds_read_b128 a[20:23], v44 offset:9216
  ds_read_b128 a[24:27], v45 offset:8192
  ds_read_b128 a[28:31], v45 offset:9216
  ds_read_b128 a[32:35], v46 offset:8192
  ds_read_b128 a[36:39], v46 offset:9216
  ds_read_b128 a[40:43], v47 offset:8192
  ds_read_b128 a[44:47], v47 offset:9216
  s_waitcnt lgkmcnt(7)
  v_mfma_f32_32x32x16_bf16 v[64:79], a[0:3], a[16:19], v[64:79]
  v_mul_u32_u24 v60, 80, v60
  v_lshrrev_b32 v61, 5, v1
  v_lshl_add_u32 v60, v61, 5, v60
  s_mul_i32 s87, s61, 5120
  s_add_u32 s87, s87, 73728
  s_waitcnt lgkmcnt(6)
  v_mfma_f32_32x32x16_bf16 v[80:95], a[0:3], a[20:23], v[80:95]
  v_add_u32 v11, s87, v60
  v_lshrrev_b32 v61, 5, v1
  v_lshlrev_b32 v61, 3, v61
  v_bfe_u32 v62, v1, 2, 2
  v_add_u32 v61, v61, v62
  s_waitcnt lgkmcnt(5)
  v_mfma_f32_32x32x16_bf16 v[64:79], a[4:7], a[24:27], v[64:79]
  v_mul_u32_u24 v61, 80, v61
  v_and_b32 v62, 1, v1
  v_lshlrev_b32 v62, 5, v62
  v_bfe_u32 v63, v1, 4, 1
  v_lshlrev_b32 v63, 4, v63
  s_waitcnt lgkmcnt(4)
  v_mfma_f32_32x32x16_bf16 v[80:95], a[4:7], a[28:31], v[80:95]
  v_add3_u32 v61, v61, v62, v63
  v_bfe_u32 v62, v1, 1, 1
  v_lshlrev_b32 v62, 3, v62
  v_add3_u32 v12, v61, v62, s87
  v_mov_b32 v44, 0
  global_load_dwordx2 v[34:35], v44, s[32:33] sc1
  s_waitcnt lgkmcnt(3)
  v_mfma_f32_32x32x16_bf16 v[64:79], a[8:11], a[32:35], v[64:79]
  s_waitcnt lgkmcnt(2)
  v_mfma_f32_32x32x16_bf16 v[80:95], a[8:11], a[36:39], v[80:95]
  s_waitcnt lgkmcnt(1)
  v_mfma_f32_32x32x16_bf16 v[64:79], a[12:15], a[40:43], v[64:79]
  s_waitcnt lgkmcnt(0)
  v_mfma_f32_32x32x16_bf16 v[80:95], a[12:15], a[44:47], v[80:95]
  s_waitcnt lgkmcnt(0)
  s_barrier
  ds_read_b128 a[0:3], v2 offset:0
  ds_read_b128 a[4:7], v3 offset:0
  ds_read_b128 a[8:11], v4 offset:0
  ds_read_b128 a[12:15], v5 offset:0
  ds_read_b128 a[16:19], v6 offset:0
  ds_read_b128 a[20:23], v6 offset:1024
  ds_read_b128 a[24:27], v7 offset:0
  ds_read_b128 a[28:31], v7 offset:1024
  ds_read_b128 a[32:35], v8 offset:0
  ds_read_b128 a[36:39], v8 offset:1024
  ds_read_b128 a[40:43], v9 offset:0
  ds_read_b128 a[44:47], v9 offset:1024
  s_waitcnt lgkmcnt(7)
  v_mfma_f32_32x32x16_bf16 v[64:79], a[0:3], a[16:19], v[64:79]
  s_waitcnt lgkmcnt(6)
  v_mfma_f32_32x32x16_bf16 v[80:95], a[0:3], a[20:23], v[80:95]
  s_waitcnt lgkmcnt(5)
  v_mfma_f32_32x32x16_bf16 v[64:79], a[4:7], a[24:27], v[64:79]
  s_waitcnt lgkmcnt(4)
  v_mfma_f32_32x32x16_bf16 v[80:95], a[4:7], a[28:31], v[80:95]
  s_waitcnt lgkmcnt(3)
  v_mfma_f32_32x32x16_bf16 v[64:79], a[8:11], a[32:35], v[64:79]
  s_waitcnt lgkmcnt(2)
  v_mfma_f32_32x32x16_bf16 v[80:95], a[8:11], a[36:39], v[80:95]
  s_waitcnt lgkmcnt(1)
  v_mfma_f32_32x32x16_bf16 v[64:79], a[12:15], a[40:43], v[64:79]
  s_waitcnt lgkmcnt(0)
  v_mfma_f32_32x32x16_bf16 v[80:95], a[12:15], a[44:47], v[80:95]
  s_waitcnt lgkmcnt(0)
  s_barrier
  ds_read_b128 a[0:3], v2 offset:24576
  ds_read_b128 a[4:7], v3 offset:24576
  ds_read_b128 a[8:11], v4 offset:24576
  ds_read_b128 a[12:15], v5 offset:24576
  ds_read_b128 a[16:19], v6 offset:24576
  ds_read_b128 a[20:23], v6 offset:25600
  ds_read_b128 a[24:27], v7 offset:24576
  ds_read_b128 a[28:31], v7 offset:25600
  ds_read_b128 a[32:35], v8 offset:24576
  ds_read_b128 a[36:39], v8 offset:25600
  ds_read_b128 a[40:43], v9 offset:24576
  ds_read_b128 a[44:47], v9 offset:25600
  s_waitcnt lgkmcnt(7)
  v_mfma_f32_32x32x16_bf16 v[64:79], a[0:3], a[16:19], v[64:79]
  s_waitcnt lgkmcnt(6)
  v_mfma_f32_32x32x16_bf16 v[80:95], a[0:3], a[20:23], v[80:95]
  s_waitcnt lgkmcnt(5)
  v_mfma_f32_32x32x16_bf16 v[64:79], a[4:7], a[24:27], v[64:79]
  s_waitcnt lgkmcnt(4)
  v_mfma_f32_32x32x16_bf16 v[80:95], a[4:7], a[28:31], v[80:95]
  s_waitcnt lgkmcnt(3)
  v_mfma_f32_32x32x16_bf16 v[64:79], a[8:11], a[32:35], v[64:79]
  s_waitcnt lgkmcnt(2)
  v_mfma_f32_32x32x16_bf16 v[80:95], a[8:11], a[36:39], v[80:95]
  s_waitcnt lgkmcnt(1)
  v_mfma_f32_32x32x16_bf16 v[64:79], a[12:15], a[40:43], v[64:79]
  s_waitcnt lgkmcnt(0)
  v_mfma_f32_32x32x16_bf16 v[80:95], a[12:15], a[44:47], v[80:95]
  s_waitcnt lgkmcnt(0)
  s_barrier
  ds_read_b128 a[0:3], v2 offset:49152
  ds_read_b128 a[4:7], v3 offset:49152
  ds_read_b128 a[8:11], v4 offset:49152
  ds_read_b128 a[12:15], v5 offset:49152
  ds_read_b128 a[16:19], v6 offset:49152
  ds_read_b128 a[20:23], v6 offset:50176
  ds_read_b128 a[24:27], v7 offset:49152
  ds_read_b128 a[28:31], v7 offset:50176
  ds_read_b128 a[32:35], v8 offset:49152
  ds_read_b128 a[36:39], v8 offset:50176
  ds_read_b128 a[40:43], v9 offset:49152
  ds_read_b128 a[44:47], v9 offset:50176
  s_waitcnt lgkmcnt(7)
  v_mfma_f32_32x32x16_bf16 v[64:79], a[0:3], a[16:19], v[64:79]
  s_waitcnt lgkmcnt(6)
  v_mfma_f32_32x32x16_bf16 v[80:95], a[0:3], a[20:23], v[80:95]
  s_waitcnt lgkmcnt(5)
  v_mfma_f32_32x32x16_bf16 v[64:79], a[4:7], a[24:27], v[64:79]
  s_waitcnt lgkmcnt(4)
  v_mfma_f32_32x32x16_bf16 v[80:95], a[4:7], a[28:31], v[80:95]
  s_waitcnt lgkmcnt(3)
  v_mfma_f32_32x32x16_bf16 v[64:79], a[8:11], a[32:35], v[64:79]
  s_waitcnt lgkmcnt(2)
  v_mfma_f32_32x32x16_bf16 v[80:95], a[8:11], a[36:39], v[80:95]
  s_waitcnt lgkmcnt(1)
  v_mfma_f32_32x32x16_bf16 v[64:79], a[12:15], a[40:43], v[64:79]
  s_waitcnt lgkmcnt(0)
  v_mfma_f32_32x32x16_bf16 v[80:95], a[12:15], a[44:47], v[80:95]
  s_waitcnt lgkmcnt(0)
  s_barrier
  v_add_u32 v44, 0x10000, v2
  v_add_u32 v45, 0x10000, v3
  v_add_u32 v46, 0x10000, v4
  v_add_u32 v47, 0x10000, v5
  ds_read_b128 a[0:3], v44 offset:8192
  ds_read_b128 a[4:7], v45 offset:8192
  ds_read_b128 a[8:11], v46 offset:8192
  ds_read_b128 a[12:15], v47 offset:8192
  v_add_u32 v44, 0x10000, v6
  v_add_u32 v45, 0x10000, v7
  v_add_u32 v46, 0x10000, v8
  v_add_u32 v47, 0x10000, v9
  ds_read_b128 a[16:19], v44 offset:8192
  ds_read_b128 a[20:23], v44 offset:9216
  ds_read_b128 a[24:27], v45 offset:8192
  ds_read_b128 a[28:31], v45 offset:9216
  ds_read_b128 a[32:35], v46 offset:8192
  ds_read_b128 a[36:39], v46 offset:9216
  ds_read_b128 a[40:43], v47 offset:8192
  ds_read_b128 a[44:47], v47 offset:9216
  s_waitcnt lgkmcnt(7)
  v_mfma_f32_32x32x16_bf16 v[64:79], a[0:3], a[16:19], v[64:79]
  s_waitcnt lgkmcnt(6)
  v_mfma_f32_32x32x16_bf16 v[80:95], a[0:3], a[20:23], v[80:95]
  s_waitcnt lgkmcnt(5)
  v_mfma_f32_32x32x16_bf16 v[64:79], a[4:7], a[24:27], v[64:79]
  s_waitcnt lgkmcnt(4)
  v_mfma_f32_32x32x16_bf16 v[80:95], a[4:7], a[28:31], v[80:95]
  s_waitcnt lgkmcnt(3)
  v_mfma_f32_32x32x16_bf16 v[64:79], a[8:11], a[32:35], v[64:79]
  s_waitcnt lgkmcnt(2)
  v_mfma_f32_32x32x16_bf16 v[80:95], a[8:11], a[36:39], v[80:95]
  s_waitcnt lgkmcnt(1)
  v_mfma_f32_32x32x16_bf16 v[64:79], a[12:15], a[40:43], v[64:79]
  s_waitcnt lgkmcnt(0)
  v_mfma_f32_32x32x16_bf16 v[80:95], a[12:15], a[44:47], v[80:95]
  s_waitcnt vmcnt(0)
  s_nop 8
  v_mov_b32 v38, v64
  s_nop 0
  v_mov_b32 v39, v80
  v_fma_f32 v44, v16, v38, v68
  v_fma_f32 v45, v16, v39, v84
  v_fma_f32 v40, -v17, v39, v44
  v_fma_f32 v41, v17, v38, v45
  v_fma_f32 v44, v16, v40, v72
  v_fma_f32 v45, v16, v41, v88
  v_fma_f32 v38, -v17, v41, v44
  v_fma_f32 v39, v17, v40, v45
  v_fma_f32 v44, v16, v38, v76
  v_fma_f32 v45, v16, v39, v92
  v_fma_f32 v40, -v17, v39, v44
  v_fma_f32 v41, v17, v38, v45
  v_fma_f32 v44, v16, v40, v65
  v_fma_f32 v45, v16, v41, v81
  v_fma_f32 v38, -v17, v41, v44
  v_fma_f32 v39, v17, v40, v45
  v_fma_f32 v44, v16, v38, v69
  v_fma_f32 v45, v16, v39, v85
  v_fma_f32 v40, -v17, v39, v44
  v_fma_f32 v41, v17, v38, v45
  v_fma_f32 v44, v16, v40, v73
  v_fma_f32 v45, v16, v41, v89
  v_fma_f32 v38, -v17, v41, v44
  v_fma_f32 v39, v17, v40, v45
  v_fma_f32 v44, v16, v38, v77
  v_fma_f32 v45, v16, v39, v93
  v_fma_f32 v40, -v17, v39, v44
  v_fma_f32 v41, v17, v38, v45
  v_fma_f32 v44, v16, v40, v66
  v_fma_f32 v45, v16, v41, v82
  v_fma_f32 v38, -v17, v41, v44
  v_fma_f32 v39, v17, v40, v45
  v_fma_f32 v44, v16, v38, v70
  v_fma_f32 v45, v16, v39, v86
  v_fma_f32 v40, -v17, v39, v44
  v_fma_f32 v41, v17, v38, v45
  v_fma_f32 v44, v16, v40, v74
  v_fma_f32 v45, v16, v41, v90
  v_fma_f32 v38, -v17, v41, v44
  v_fma_f32 v39, v17, v40, v45
  v_fma_f32 v44, v16, v38, v78
  v_fma_f32 v45, v16, v39, v94
  v_fma_f32 v40, -v17, v39, v44
  v_fma_f32 v41, v17, v38, v45
  v_fma_f32 v44, v16, v40, v67
  v_fma_f32 v45, v16, v41, v83
  v_fma_f32 v38, -v17, v41, v44
  v_fma_f32 v39, v17, v40, v45
  v_fma_f32 v44, v16, v38, v71
  v_fma_f32 v45, v16, v39, v87
  v_fma_f32 v40, -v17, v39, v44
  v_fma_f32 v41, v17, v38, v45
  v_fma_f32 v44, v16, v40, v75
  v_fma_f32 v45, v16, v41, v91
  v_fma_f32 v38, -v17, v41, v44
  v_fma_f32 v39, v17, v40, v45
  v_fma_f32 v44, v16, v38, v79
  v_fma_f32 v45, v16, v39, v95
  v_fma_f32 v40, -v17, v39, v44
  v_fma_f32 v41, v17, v38, v45
  v_mov_b32 v42, v40
  v_mov_b32 v43, v41
  v_mov_b32 v38, v40
  v_mov_b32 v39, v41
  s_nop 0
  v_permlane32_swap_b32 v42, v38
  v_permlane32_swap_b32 v43, v39
  v_fma_f32 v44, v20, v42, v38
  v_fma_f32 v45, v20, v43, v39
  v_fma_f32 v40, -v21, v43, v44
  v_fma_f32 v41, v21, v42, v45
  v_mul_f32 v42, v42, v32
  v_mul_f32 v43, v43, v32
  v_and_b32 v62, 31, v1
  v_lshlrev_b32 v62, 3, v62
  v_add_u32 v62, 73728, v62
  s_lshl_b32 s87, s61, 8
  v_add_u32 v63, s87, v62
  s_barrier
  ds_write_b64 v63, v[40:41] offset:0
  s_waitcnt lgkmcnt(0)
  s_barrier
  ds_read_b64 v[48:49], v62 offset:0
  ds_read_b64 v[50:51], v62 offset:256
  ds_read_b64 v[52:53], v62 offset:512
  ds_read_b64 v[54:55], v62 offset:768
  s_waitcnt lgkmcnt(2)
  v_fma_f32 v44, v22, v48, v50
  v_fma_f32 v45, v22, v49, v51
  v_fma_f32 v56, -v23, v49, v44
  v_fma_f32 v57, v23, v48, v45
  s_waitcnt lgkmcnt(1)
  v_fma_f32 v44, v22, v56, v52
  v_fma_f32 v45, v22, v57, v53
  v_fma_f32 v58, -v23, v57, v44
  v_fma_f32 v59, v23, v56, v45
  s_waitcnt lgkmcnt(0)
  v_fma_f32 v44, v22, v58, v54
  v_fma_f32 v45, v22, v59, v55
  v_fma_f32 v60, -v23, v59, v44
  v_fma_f32 v61, v23, v58, v45
  v_cndmask_b32 v38, 0, v48, s[80:81]
  v_cndmask_b32 v38, v38, v56, s[82:83]
  v_cndmask_b32 v38, v38, v58, s[84:85]
  v_cndmask_b32 v39, 0, v49, s[80:81]
  v_cndmask_b32 v39, v39, v57, s[82:83]
  v_cndmask_b32 v39, v39, v59, s[84:85]
  v_fma_f32 v44, v28, v38, v42
  v_fma_f32 v45, v28, v39, v43
  v_fma_f32 v36, -v29, v39, v44
  v_fma_f32 v37, v29, v38, v45
  s_lshl_b32 s87, s62, 13
  v_add_u32 v44, s87, v10
  v_lshrrev_b32 v45, 3, v1
  v_cmp_ne_u32 vcc, 0, v35
  s_cbranch_vccnz L_k1_nonce_ok
  s_mov_b32 s98, 0
L_k1_nonce_retry:
  v_mov_b32 v46, 0
  global_load_dwordx2 v[34:35], v46, s[32:33] sc1
  s_waitcnt vmcnt(0)
  s_add_u32 s98, s98, 1
  s_cmp_gt_u32 s98, 40000
  s_cbranch_scc1 L_k1_nonce_ok
  v_cmp_ne_u32 vcc, 0, v35
  s_cbranch_vccz L_k1_nonce_retry
L_k1_nonce_ok:
  v_mov_b32 v62, v34
  v_mov_b32 v63, v35
  v_cmp_eq_u32 vcc, s61, v45
  s_nop 0
  s_and_saveexec_b64 s[88:89], vcc
  global_store_dwordx4 v44, v[60:63], s[34:35] sc0 sc1
  s_mov_b64 exec, s[88:89]
  s_barrier
  s_lshr_b32 s72, s63, 3
  s_and_b32 s73, s63, 7
  s_mov_b32 s40, s14
  s_mov_b32 s41, s15
  s_mov_b32 s42, 524288
  s_mov_b32 s43, 0x20000
  s_mov_b32 s44, s16
  s_mov_b32 s45, s17
  s_mov_b32 s46, 524288
  s_mov_b32 s47, 0x20000
  v_and_b32 v48, 7, v1
  v_lshrrev_b32 v49, 4, v1
  v_xor_b32 v48, v48, v49
  v_lshlrev_b32 v48, 4, v48
  v_lshrrev_b32 v49, 3, v1
  v_lshlrev_b32 v49, 10, v49
  v_add_u32 v2, v48, v49
  v_xor_b32 v3, 64, v2
  s_lshl_b32 s76, s73, 16
  s_lshl_b32 s68, s72, 9
  s_add_u32 s76, s76, s68
  s_lshl_b32 s68, s61, 7
  s_add_u32 s76, s76, s68
  s_lshl_b32 s75, s61, 13
  s_add_u32 s75, s75, 98304
  v_and_b32 v48, 31, v1
  v_lshlrev_b32 v48, 7, v48
  v_add_u32 v48, s75, v48
  v_lshrrev_b32 v49, 5, v1
  v_bfe_u32 v50, v1, 1, 3
  v_xor_b32 v50, v49, v50
  v_xor_b32 v49, 0, v50
  v_lshl_add_u32 v4, v49, 4, v48
  v_xor_b32 v49, 2, v50
  v_lshl_add_u32 v5, v49, 4, v48
  v_xor_b32 v49, 4, v50
  v_lshl_add_u32 v6, v49, 4, v48
  v_xor_b32 v49, 6, v50
  v_lshl_add_u32 v7, v49, 4, v48
  s_mov_b32 s56, s26
  s_mov_b32 s57, s27
  s_mov_b32 s58, 1835008
  s_mov_b32 s59, 0x20000
  v_bfe_u32 v48, v1, 4, 1
  v_lshlrev_b32 v48, 2, v48
  v_and_b32 v49, 7, v1
  v_xor_b32 v48, v48, v49
  v_lshlrev_b32 v48, 4, v48
  v_lshrrev_b32 v49, 3, v1
  v_lshlrev_b32 v49, 10, v49
  v_add_u32 v8, v48, v49
  v_add_u32 v9, 7168, v8
  s_lshl_b32 s68, s72, 2
  s_add_u32 s68, s68, s61
  s_mul_i32 s77, s68, 229376
  s_lshl_b32 s68, s73, 7
  s_add_u32 s77, s77, s68
  s_barrier
  s_add_u32 m0, s75, 0
  s_add_u32 s68, s76, 0
  buffer_load_dwordx4 v2, s[40:43], s68 offen lds
  s_add_u32 m0, s75, 1024
  s_add_u32 s68, s76, 8192
  buffer_load_dwordx4 v3, s[40:43], s68 offen lds
  s_add_u32 m0, s75, 2048
  s_add_u32 s68, s76, 16384
  buffer_load_dwordx4 v2, s[40:43], s68 offen lds
  s_add_u32 m0, s75, 3072
  s_add_u32 s68, s76, 24576
  buffer_load_dwordx4 v3, s[40:43], s68 offen lds
  s_add_u32 m0, s75, 4096
  s_add_u32 s68, s76, 32768
  buffer_load_dwordx4 v2, s[40:43], s68 offen lds
  s_add_u32 m0, s75, 5120
  s_add_u32 s68, s76, 40960
  buffer_load_dwordx4 v3, s[40:43], s68 offen lds
  s_add_u32 m0, s75, 6144
  s_add_u32 s68, s76, 49152
  buffer_load_dwordx4 v2, s[40:43], s68 offen lds
  s_add_u32 m0, s75, 7168
  s_add_u32 s68, s76, 57344
  buffer_load_dwordx4 v3, s[40:43], s68 offen lds
  s_barrier
  s_add_u32 m0, s75, 32768
  s_add_u32 s68, s76, 0
  buffer_load_dwordx4 v2, s[44:47], s68 offen lds
  s_add_u32 m0, s75, 33792
  s_add_u32 s68, s76, 8192
  buffer_load_dwordx4 v3, s[44:47], s68 offen lds
  s_add_u32 m0, s75, 34816
  s_add_u32 s68, s76, 16384
  buffer_load_dwordx4 v2, s[44:47], s68 offen lds
  s_add_u32 m0, s75, 35840
  s_add_u32 s68, s76, 24576
  buffer_load_dwordx4 v3, s[44:47], s68 offen lds
  s_add_u32 m0, s75, 36864
  s_add_u32 s68, s76, 32768
  buffer_load_dwordx4 v2, s[44:47], s68 offen lds
  s_add_u32 m0, s75, 37888
  s_add_u32 s68, s76, 40960
  buffer_load_dwordx4 v3, s[44:47], s68 offen lds
  s_add_u32 m0, s75, 38912
  s_add_u32 s68, s76, 49152
  buffer_load_dwordx4 v2, s[44:47], s68 offen lds
  s_add_u32 m0, s75, 39936
  s_add_u32 s68, s76, 57344
  buffer_load_dwordx4 v3, s[44:47], s68 offen lds
  s_waitcnt vmcnt(8)
  ds_read_b128 a[0:3], v4 offset:0
  ds_read_b128 a[4:7], v4 offset:4096
  ds_read_b128 a[8:11], v5 offset:0
  ds_read_b128 a[12:15], v5 offset:4096
  ds_read_b128 a[32:35], v6 offset:0
  ds_read_b128 a[36:39], v6 offset:4096
  ds_read_b128 a[40:43], v7 offset:0
  ds_read_b128 a[44:47], v7 offset:4096
  s_waitcnt lgkmcnt(0)
  s_add_u32 m0, s75, 0
  s_add_u32 s68, s77, 0
  buffer_load_dwordx4 v8, s[56:59], s68 offen lds
  buffer_load_dwordx4 v9, s[56:59], s68 offen offset:1024 lds
  s_add_u32 m0, s75, 2048
  s_add_u32 s68, s77, 16384
  buffer_load_dwordx4 v8, s[56:59], s68 offen lds
  buffer_load_dwordx4 v9, s[56:59], s68 offen offset:1024 lds
  s_add_u32 m0, s75, 4096
  s_add_u32 s68, s77, 32768
  buffer_load_dwordx4 v8, s[56:59], s68 offen lds
  buffer_load_dwordx4 v9, s[56:59], s68 offen offset:1024 lds
  s_add_u32 m0, s75, 6144
  s_add_u32 s68, s77, 49152
  buffer_load_dwordx4 v8, s[56:59], s68 offen lds
  buffer_load_dwordx4 v9, s[56:59], s68 offen offset:1024 lds
  s_cmp_eq_u32 s62, 0
  s_cbranch_scc1 L_k1_lb_zero
  s_mov_b32 s98, 0
L_k1_lb_again:
  s_sub_u32 s87, s62, 1
  s_lshl_b32 s87, s87, 13
  v_lshrrev_b32 v48, 5, v1
  v_lshlrev_b32 v48, 13, v48
  v_sub_u32 v48, s87, v48
  v_add_u32 v48, v10, v48
  v_max_i32 v49, v48, v10
  global_load_dwordx4 v[96:99], v49, s[34:35] sc1
  v_subrev_u32 v48, 16384, v48
  v_max_i32 v49, v48, v10
  global_load_dwordx4 v[100:103], v49, s[34:35] sc1
  v_subrev_u32 v48, 16384, v48
  v_max_i32 v49, v48, v10
  global_load_dwordx4 v[104:107], v49, s[34:35] sc1
  v_subrev_u32 v48, 16384, v48
  v_max_i32 v49, v48, v10
  global_load_dwordx4 v[108:111], v49, s[34:35] sc1
  v_subrev_u32 v48, 16384, v48
  v_max_i32 v49, v48, v10
  global_load_dwordx4 v[112:115], v49, s[34:35] sc1
  v_subrev_u32 v48, 16384, v48
  v_max_i32 v49, v48, v10
  global_load_dwordx4 v[116:119], v49, s[34:35] sc1
  v_subrev_u32 v48, 16384, v48
  v_max_i32 v49, v48, v10
  global_load_dwordx4 v[120:123], v49, s[34:35] sc1
  v_subrev_u32 v48, 16384, v48
  v_max_i32 v49, v48, v10
  global_load_dwordx4 v[124:127], v49, s[34:35] sc1
  s_waitcnt vmcnt(0)
  s_mov_b64 s[88:89], -1
  s_cmp_le_u32 s62, 0
  s_cbranch_scc1 L_k1_lb_checked
  s_cmp_ge_u32 s62, 2
  s_cselect_b32 s69, 0, -1
  v_cmp_eq_u32 vcc, v98, v34
  v_cmp_eq_u32 s[70:71], v99, v35
  s_nop 0
  s_and_b64 vcc, vcc, s[70:71]
  s_or_b32 vcc_hi, vcc_hi, s69
  s_and_b64 s[88:89], s[88:89], vcc
  s_cmp_le_u32 s62, 2
  s_cbranch_scc1 L_k1_lb_checked
  s_cmp_ge_u32 s62, 4
  s_cselect_b32 s69, 0, -1
  v_cmp_eq_u32 vcc, v102, v34
  v_cmp_eq_u32 s[70:71], v103, v35
  s_nop 0
  s_and_b64 vcc, vcc, s[70:71]
  s_or_b32 vcc_hi, vcc_hi, s69
  s_and_b64 s[88:89], s[88:89], vcc
  s_cmp_le_u32 s62, 4
  s_cbranch_scc1 L_k1_lb_checked
  s_cmp_ge_u32 s62, 6
  s_cselect_b32 s69, 0, -1
  v_cmp_eq_u32 vcc, v106, v34
  v_cmp_eq_u32 s[70:71], v107, v35
  s_nop 0
  s_and_b64 vcc, vcc, s[70:71]
  s_or_b32 vcc_hi, vcc_hi, s69
  s_and_b64 s[88:89], s[88:89], vcc
  s_cmp_le_u32 s62, 6
  s_cbranch_scc1 L_k1_lb_checked
  s_cmp_ge_u32 s62, 8
  s_cselect_b32 s69, 0, -1
  v_cmp_eq_u32 vcc, v110, v34
  v_cmp_eq_u32 s[70:71], v111, v35
  s_nop 0
  s_and_b64 vcc, vcc, s[70:71]
  s_or_b32 vcc_hi, vcc_hi, s69
  s_and_b64 s[88:89], s[88:89], vcc
  s_cmp_le_u32 s62, 8
  s_cbranch_scc1 L_k1_lb_checked
  s_cmp_ge_u32 s62, 10
  s_cselect_b32 s69, 0, -1
  v_cmp_eq_u32 vcc, v114, v34
  v_cmp_eq_u32 s[70:71], v115, v35
  s_nop 0
  s_and_b64 vcc, vcc, s[70:71]
  s_or_b32 vcc_hi, vcc_hi, s69
  s_and_b64 s[88:89], s[88:89], vcc
  s_cmp_le_u32 s62, 10
  s_cbranch_scc1 L_k1_lb_checked
  s_cmp_ge_u32 s62, 12
  s_cselect_b32 s69, 0, -1
  v_cmp_eq_u32 vcc, v118, v34
  v_cmp_eq_u32 s[70:71], v119, v35
  s_nop 0
  s_and_b64 vcc, vcc, s[70:71]
  s_or_b32 vcc_hi, vcc_hi, s69
  s_and_b64 s[88:89], s[88:89], vcc
  s_cmp_le_u32 s62, 12
  s_cbranch_scc1 L_k1_lb_checked
  s_cmp_ge_u32 s62, 14
  s_cselect_b32 s69, 0, -1
  v_cmp_eq_u32 vcc, v122, v34
  v_cmp_eq_u32 s[70:71], v123, v35
  s_nop 0
  s_and_b64 vcc, vcc, s[70:71]
  s_or_b32 vcc_hi, vcc_hi, s69
  s_and_b64 s[88:89], s[88:89], vcc
  s_cmp_le_u32 s62, 14
  s_cbranch_scc1 L_k1_lb_checked
  s_cmp_ge_u32 s62, 16
  s_cselect_b32 s69, 0, -1
  v_cmp_eq_u32 vcc, v126, v34
  v_cmp_eq_u32 s[70:71], v127, v35
  s_nop 0
  s_and_b64 vcc, vcc, s[70:71]
  s_or_b32 vcc_hi, vcc_hi, s69
  s_and_b64 s[88:89], s[88:89], vcc
L_k1_lb_checked:
  s_cmp_eq_u64 s[88:89], -1
  s_cbranch_scc1 L_k1_lb_ok
  s_add_u32 s98, s98, 1
  s_cmp_gt_u32 s98, 40000
  s_cbranch_scc1 L_k1_lb_ok
  s_sleep 4
  s_branch L_k1_lb_again
L_k1_lb_ok:
  v_mov_b32 v40, 0
  v_mov_b32 v41, 0
  s_cmp_le_u32 s62, 14
  s_cbranch_scc1 L_k1_lb_h7
  s_cmp_ge_u32 s62, 16
  s_cselect_b32 s71, -1, 0
  s_mov_b32 s70, -1
  v_cndmask_b32 v124, 0, v124, s[70:71]
  v_cndmask_b32 v125, 0, v125, s[70:71]
  v_fma_f32 v44, v26, v40, v124
  v_fma_f32 v45, v26, v41, v125
  v_fma_f32 v44, -v27, v41, v44
  v_fma_f32 v41, v27, v40, v45
  v_mov_b32 v40, v44
L_k1_lb_h7:
  s_cmp_le_u32 s62, 12
  s_cbranch_scc1 L_k1_lb_h6
  s_cmp_ge_u32 s62, 14
  s_cselect_b32 s71, -1, 0
  s_mov_b32 s70, -1
  v_cndmask_b32 v120, 0, v120, s[70:71]
  v_cndmask_b32 v121, 0, v121, s[70:71]
  v_fma_f32 v44, v26, v40, v120
  v_fma_f32 v45, v26, v41, v121
  v_fma_f32 v44, -v27, v41, v44
  v_fma_f32 v41, v27, v40, v45
  v_mov_b32 v40, v44
L_k1_lb_h6:
  s_cmp_le_u32 s62, 10
  s_cbranch_scc1 L_k1_lb_h5
  s_cmp_ge_u32 s62, 12
  s_cselect_b32 s71, -1, 0
  s_mov_b32 s70, -1
  v_cndmask_b32 v116, 0, v116, s[70:71]
  v_cndmask_b32 v117, 0, v117, s[70:71]
  v_fma_f32 v44, v26, v40, v116
  v_fma_f32 v45, v26, v41, v117
  v_fma_f32 v44, -v27, v41, v44
  v_fma_f32 v41, v27, v40, v45
  v_mov_b32 v40, v44
L_k1_lb_h5:
  s_cmp_le_u32 s62, 8
  s_cbranch_scc1 L_k1_lb_h4
  s_cmp_ge_u32 s62, 10
  s_cselect_b32 s71, -1, 0
  s_mov_b32 s70, -1
  v_cndmask_b32 v112, 0, v112, s[70:71]
  v_cndmask_b32 v113, 0, v113, s[70:71]
  v_fma_f32 v44, v26, v40, v112
  v_fma_f32 v45, v26, v41, v113
  v_fma_f32 v44, -v27, v41, v44
  v_fma_f32 v41, v27, v40, v45
  v_mov_b32 v40, v44
L_k1_lb_h4:
  s_cmp_le_u32 s62, 6
  s_cbranch_scc1 L_k1_lb_h3
  s_cmp_ge_u32 s62, 8
  s_cselect_b32 s71, -1, 0
  s_mov_b32 s70, -1
  v_cndmask_b32 v108, 0, v108, s[70:71]
  v_cndmask_b32 v109, 0, v109, s[70:71]
  v_fma_f32 v44, v26, v40, v108
  v_fma_f32 v45, v26, v41, v109
  v_fma_f32 v44, -v27, v41, v44
  v_fma_f32 v41, v27, v40, v45
  v_mov_b32 v40, v44
L_k1_lb_h3:
  s_cmp_le_u32 s62, 4
  s_cbranch_scc1 L_k1_lb_h2
  s_cmp_ge_u32 s62, 6
  s_cselect_b32 s71, -1, 0
  s_mov_b32 s70, -1
  v_cndmask_b32 v104, 0, v104, s[70:71]
  v_cndmask_b32 v105, 0, v105, s[70:71]
  v_fma_f32 v44, v26, v40, v104
  v_fma_f32 v45, v26, v41, v105
  v_fma_f32 v44, -v27, v41, v44
  v_fma_f32 v41, v27, v40, v45
  v_mov_b32 v40, v44
L_k1_lb_h2:
  s_cmp_le_u32 s62, 2
  s_cbranch_scc1 L_k1_lb_h1
  s_cmp_ge_u32 s62, 4
  s_cselect_b32 s71, -1, 0
  s_mov_b32 s70, -1
  v_cndmask_b32 v100, 0, v100, s[70:71]
  v_cndmask_b32 v101, 0, v101, s[70:71]
  v_fma_f32 v44, v26, v40, v100
  v_fma_f32 v45, v26, v41, v101
  v_fma_f32 v44, -v27, v41, v44
  v_fma_f32 v41, v27, v40, v45
  v_mov_b32 v40, v44
L_k1_lb_h1:
  s_cmp_le_u32 s62, 0
  s_cbranch_scc1 L_k1_lb_h0
  s_cmp_ge_u32 s62, 2
  s_cselect_b32 s71, -1, 0
  s_mov_b32 s70, -1
  v_cndmask_b32 v96, 0, v96, s[70:71]
  v_cndmask_b32 v97, 0, v97, s[70:71]
  v_fma_f32 v44, v26, v40, v96
  v_fma_f32 v45, v26, v41, v97
  v_fma_f32 v44, -v27, v41, v44
  v_fma_f32 v41, v27, v40, v45
  v_mov_b32 v40, v44
L_k1_lb_h0:
  v_mov_b32 v42, v40
  v_mov_b32 v43, v41
  s_nop 0
  v_permlane32_swap_b32 v40, v42
  v_permlane32_swap_b32 v41, v43
  v_fma_f32 v44, v24, v42, v40
  v_fma_f32 v45, v24, v43, v41
  v_fma_f32 v48, -v25, v43, v44
  v_fma_f32 v49, v25, v42, v45
  v_fma_f32 v44, v30, v48, v36
  v_fma_f32 v45, v30, v49, v37
  v_fma_f32 v38, -v31, v49, v44
  v_fma_f32 v39, v31, v48, v45
  s_branch L_k1_lb_done
L_k1_lb_zero:
  v_mov_b32 v38, v36
  v_mov_b32 v39, v37
L_k1_lb_done:
  s_waitcnt vmcnt(8)
  ds_read_b128 a[16:19], v4 offset:32768
  ds_read_b128 a[20:23], v4 offset:36864
  ds_read_b128 a[24:27], v5 offset:32768
  ds_read_b128 a[28:31], v5 offset:36864
  ds_read_b128 a[48:51], v6 offset:32768
  ds_read_b128 a[52:55], v6 offset:36864
  ds_read_b128 a[56:59], v7 offset:32768
  ds_read_b128 a[60:63], v7 offset:36864
  s_waitcnt lgkmcnt(0)
  s_add_u32 m0, s75, 32768
  s_add_u32 s68, s77, 65536
  buffer_load_dwordx4 v8, s[56:59], s68 offen lds
  buffer_load_dwordx4 v9, s[56:59], s68 offen offset:1024 lds
  s_add_u32 m0, s75, 34816
  s_add_u32 s68, s77, 81920
  buffer_load_dwordx4 v8, s[56:59], s68 offen lds
  buffer_load_dwordx4 v9, s[56:59], s68 offen offset:1024 lds
  s_add_u32 m0, s75, 36864
  s_add_u32 s68, s77, 98304
  buffer_load_dwordx4 v8, s[56:59], s68 offen lds
  buffer_load_dwordx4 v9, s[56:59], s68 offen offset:1024 lds
  s_add_u32 m0, s75, 38912
  s_add_u32 s68, s77, 114688
  buffer_load_dwordx4 v8, s[56:59], s68 offen lds
  buffer_load_dwordx4 v9, s[56:59], s68 offen offset:1024 lds
  v_fma_f32 v44, v16, v38, v64
  v_fma_f32 v45, v16, v39, v80
  v_fma_f32 v96, -v17, v39, v44
  v_fma_f32 v97, v17, v38, v45
  v_fma_f32 v44, v16, v96, v68
  v_fma_f32 v45, v16, v97, v84
  v_fma_f32 v104, -v17, v97, v44
  v_fma_f32 v105, v17, v96, v45
  v_fma_f32 v44, v16, v104, v72
  v_fma_f32 v45, v16, v105, v88
  v_fma_f32 v112, -v17, v105, v44
  v_fma_f32 v113, v17, v104, v45
  v_fma_f32 v44, v16, v112, v76
  v_fma_f32 v45, v16, v113, v92
  v_fma_f32 v120, -v17, v113, v44
  v_fma_f32 v121, v17, v112, v45
  v_fma_f32 v44, v16, v120, v65
  v_fma_f32 v45, v16, v121, v81
  v_fma_f32 v98, -v17, v121, v44
  v_fma_f32 v99, v17, v120, v45
  v_fma_f32 v44, v16, v98, v69
  v_fma_f32 v45, v16, v99, v85
  v_fma_f32 v106, -v17, v99, v44
  v_fma_f32 v107, v17, v98, v45
  v_fma_f32 v44, v16, v106, v73
  v_fma_f32 v45, v16, v107, v89
  v_fma_f32 v114, -v17, v107, v44
  v_fma_f32 v115, v17, v106, v45
  v_fma_f32 v44, v16, v114, v77
  v_fma_f32 v45, v16, v115, v93
  v_fma_f32 v122, -v17, v115, v44
  v_fma_f32 v123, v17, v114, v45
  v_fma_f32 v44, v16, v122, v66
  v_fma_f32 v45, v16, v123, v82
  v_fma_f32 v100, -v17, v123, v44
  v_fma_f32 v101, v17, v122, v45
  v_fma_f32 v44, v16, v100, v70
  v_fma_f32 v45, v16, v101, v86
  v_fma_f32 v108, -v17, v101, v44
  v_fma_f32 v109, v17, v100, v45
  v_fma_f32 v44, v16, v108, v74
  v_fma_f32 v45, v16, v109, v90
  v_fma_f32 v116, -v17, v109, v44
  v_fma_f32 v117, v17, v108, v45
  v_fma_f32 v44, v16, v116, v78
  v_fma_f32 v45, v16, v117, v94
  v_fma_f32 v124, -v17, v117, v44
  v_fma_f32 v125, v17, v116, v45
  v_fma_f32 v44, v16, v124, v67
  v_fma_f32 v45, v16, v125, v83
  v_fma_f32 v102, -v17, v125, v44
  v_fma_f32 v103, v17, v124, v45
  v_fma_f32 v44, v16, v102, v71
  v_fma_f32 v45, v16, v103, v87
  v_fma_f32 v110, -v17, v103, v44
  v_fma_f32 v111, v17, v102, v45
  v_fma_f32 v44, v16, v110, v75
  v_fma_f32 v45, v16, v111, v91
  v_fma_f32 v118, -v17, v111, v44
  v_fma_f32 v119, v17, v110, v45
  v_fma_f32 v44, v16, v118, v79
  v_fma_f32 v45, v16, v119, v95
  v_fma_f32 v126, -v17, v119, v44
  v_fma_f32 v127, v17, v118, v45
  v_mul_f32 v48, v18, v96
  v_mul_f32 v49, v19, v96
  v_fma_f32 v96, -v19, v97, v48
  v_fma_f32 v97, v18, v97, v49
  v_mul_f32 v50, v18, v98
  v_mul_f32 v51, v19, v98
  v_fma_f32 v98, -v19, v99, v50
  v_fma_f32 v99, v18, v99, v51
  v_mul_f32 v52, v18, v100
  v_mul_f32 v53, v19, v100
  v_fma_f32 v100, -v19, v101, v52
  v_fma_f32 v101, v18, v101, v53
  v_mul_f32 v54, v18, v102
  v_mul_f32 v55, v19, v102
  v_fma_f32 v102, -v19, v103, v54
  v_fma_f32 v103, v18, v103, v55
  v_mul_f32 v48, v18, v104
  v_mul_f32 v49, v19, v104
  v_fma_f32 v104, -v19, v105, v48
  v_fma_f32 v105, v18, v105, v49
  v_mul_f32 v50, v18, v106
  v_mul_f32 v51, v19, v106
  v_fma_f32 v106, -v19, v107, v50
  v_fma_f32 v107, v18, v107, v51
  v_mul_f32 v52, v18, v108
  v_mul_f32 v53, v19, v108
  v_fma_f32 v108, -v19, v109, v52
  v_fma_f32 v109, v18, v109, v53
  v_mul_f32 v54, v18, v110
  v_mul_f32 v55, v19, v110
  v_fma_f32 v110, -v19, v111, v54
  v_fma_f32 v111, v18, v111, v55
  v_mul_f32 v48, v18, v112
  v_mul_f32 v49, v19, v112
  v_fma_f32 v112, -v19, v113, v48
  v_fma_f32 v113, v18, v113, v49
  v_mul_f32 v50, v18, v114
  v_mul_f32 v51, v19, v114
  v_fma_f32 v114, -v19, v115, v50
  v_fma_f32 v115, v18, v115, v51
  v_mul_f32 v52, v18, v116
  v_mul_f32 v53, v19, v116
  v_fma_f32 v116, -v19, v117, v52
  v_fma_f32 v117, v18, v117, v53
  v_mul_f32 v54, v18, v118
  v_mul_f32 v55, v19, v118
  v_fma_f32 v118, -v19, v119, v54
  v_fma_f32 v119, v18, v119, v55
  v_mul_f32 v48, v18, v120
  v_mul_f32 v49, v19, v120
  v_fma_f32 v120, -v19, v121, v48
  v_fma_f32 v121, v18, v121, v49
  v_mul_f32 v50, v18, v122
  v_mul_f32 v51, v19, v122
  v_fma_f32 v122, -v19, v123, v50
  v_fma_f32 v123, v18, v123, v51
  v_mul_f32 v52, v18, v124
  v_mul_f32 v53, v19, v124
  v_fma_f32 v124, -v19, v125, v52
  v_fma_f32 v125, v18, v125, v53
  v_mul_f32 v54, v18, v126
  v_mul_f32 v55, v19, v126
  v_fma_f32 v126, -v19, v127, v54
  v_fma_f32 v127, v18, v127, v55
  v_cvt_pk_bf16_f32 v64, v96, v98
  v_cvt_pk_bf16_f32 v65, v100, v102
  v_cvt_pk_bf16_f32 v66, v104, v106
  v_cvt_pk_bf16_f32 v67, v108, v110
  v_cvt_pk_bf16_f32 v68, v112, v114
  v_cvt_pk_bf16_f32 v69, v116, v118
  v_cvt_pk_bf16_f32 v70, v120, v122
  v_cvt_pk_bf16_f32 v71, v124, v126
  ds_write_b128 v11, v[64:67] offset:1024
  ds_write_b128 v11, v[68:71] offset:1040
  v_cvt_pk_bf16_f32 v72, -v97, -v99
  v_cvt_pk_bf16_f32 v73, -v101, -v103
  v_cvt_pk_bf16_f32 v74, -v105, -v107
  v_cvt_pk_bf16_f32 v75, -v109, -v111
  v_cvt_pk_bf16_f32 v76, -v113, -v115
  v_cvt_pk_bf16_f32 v77, -v117, -v119
  v_cvt_pk_bf16_f32 v78, -v121, -v123
  v_cvt_pk_bf16_f32 v79, -v125, -v127
  ds_write_b128 v11, v[72:75] offset:3584
  ds_write_b128 v11, v[76:79] offset:3600
  s_lshl_b32 s70, s63, 12
  s_add_u32 s69, s86, s70
  s_waitcnt lgkmcnt(0)
  ds_read_b64_tr_b16 v[80:81], v12 offset:1024
  ds_read_b64_tr_b16 v[82:83], v12 offset:1344
  ds_read_b64_tr_b16 v[84:85], v12 offset:2304
  ds_read_b64_tr_b16 v[86:87], v12 offset:2624
  ds_read_b64_tr_b16 v[88:89], v12 offset:3584
  ds_read_b64_tr_b16 v[90:91], v12 offset:3904
  ds_read_b64_tr_b16 v[92:93], v12 offset:4864
  ds_read_b64_tr_b16 v[94:95], v12 offset:5184
  s_add_u32 s70, s69, 0
  s_waitcnt lgkmcnt(6)
  buffer_store_dwordx4 v[80:83], v13, s[52:55], s70 offen sc0 sc1
  s_add_u32 s70, s69, 1024
  s_waitcnt lgkmcnt(4)
  buffer_store_dwordx4 v[84:87], v13, s[52:55], s70 offen sc0 sc1
  s_add_u32 s70, s69, 2048
  s_waitcnt lgkmcnt(2)
  buffer_store_dwordx4 v[88:91], v13, s[52:55], s70 offen sc0 sc1
  s_add_u32 s70, s69, 3072
  s_waitcnt lgkmcnt(0)
  buffer_store_dwordx4 v[92:95], v13, s[52:55], s70 offen sc0 sc1
  s_waitcnt vmcnt(0) lgkmcnt(0)
  s_barrier
  s_cmp_lg_u32 s61, 0
  s_cbranch_scc1 L_p2_noflag
  s_mul_i32 s68, s62, 1024
  s_add_u32 s68, s68, 14565632
  s_lshl_b32 s69, s63, 3
  s_add_u32 s69, s69, s68
  v_mov_b32 v6, s69
  global_store_dwordx2 v6, v[34:35], s[34:35] sc0 sc1
  v_and_b32 v6, 15, v1
  v_lshlrev_b32 v6, 3, v6
  v_add_u32 v6, s68, v6
  s_mov_b32 s98, 0
  global_load_dwordx2 v[24:25], v6, s[34:35] sc1
L_p2_poll:
  s_waitcnt vmcnt(0)
  v_cmp_eq_u32 vcc, v24, v34
  v_cmp_eq_u32 s[70:71], v25, v35
  s_nop 0
  s_and_b64 vcc, vcc, s[70:71]
  s_cmp_eq_u64 vcc, -1
  s_cbranch_scc1 L_p2_polled
  global_load_dwordx2 v[24:25], v6, s[34:35] sc1
  s_add_u32 s98, s98, 1
  s_cmp_gt_u32 s98, 100000
  s_cbranch_scc0 L_p2_poll
L_p2_polled:
L_p2_noflag:
  s_mov_b32 s48, 0
  s_mov_b32 s49, 1024
  s_mov_b32 s50, 2048
  s_mov_b32 s51, 3072
  s_mov_b32 s52, 4096
  s_mov_b32 s53, 5120
  s_mov_b32 s54, 6144
  s_mov_b32 s55, 7168
  v_readfirstlane_b32 s68, v34
  s_nop 0
  s_bfe_u32 s84, s68, 0x40000
  s_bfe_u32 s85, s68, 0x40004
  s_bfe_u32 s86, s68, 0x40008
  s_bfe_u32 s87, s68, 0x4000c
  s_mov_b32 s36, s34
  s_mov_b32 s37, s35
  s_mov_b32 s38, 19022080
  s_mov_b32 s39, 0x20000
  s_xor_b32 s68, s72, 1
  s_lshl_b32 s68, s68, 1
  s_lshl_b32 s69, s62, 2
  s_add_u32 s68, s68, s69
  s_mul_i32 s68, s68, 180224
  v_lshlrev_b32 v6, 4, v1
  v_add_u32 v2, s68, v6
  v_add_u32 v3, 180224, v2
  s_lshl_b32 s68, s72, 2
  s_sub_u32 s68, s68, 2
  s_mul_i32 s68, s68, 180224
  v_add_u32 v4, s68, v2
  v_add_u32 v5, s68, v3
  s_lshl_b32 s74, s72, 2
  s_add_u32 s74, s74, s61
  s_lshl_b32 s74, s74, 13
  s_barrier
  s_add_u32 s68, s74, s48
  buffer_load_dwordx4 a[64:67], v2, s[36:39], s68 offen sc1
  buffer_load_dwordx4 a[68:71], v3, s[36:39], s68 offen sc1
  s_add_u32 s68, s74, s49
  buffer_load_dwordx4 a[72:75], v2, s[36:39], s68 offen sc1
  buffer_load_dwordx4 a[76:79], v3, s[36:39], s68 offen sc1
  s_add_u32 s68, s74, s50
  buffer_load_dwordx4 a[80:83], v2, s[36:39], s68 offen sc1
  buffer_load_dwordx4 a[84:87], v3, s[36:39], s68 offen sc1
  s_add_u32 s68, s74, s51
  buffer_load_dwordx4 a[88:91], v2, s[36:39], s68 offen sc1
  buffer_load_dwordx4 a[92:95], v3, s[36:39], s68 offen sc1
  v_bfe_u32 v6, v1, 3, 2
  v_and_b32 v7, 7, v1
  v_lshl_add_u32 v8, v7, 2, v6
  s_xor_b32 s68, s72, 1
  s_lshl_b32 s68, s68, 6
  s_lshl_b32 s69, s62, 7
  s_add_u32 s68, s68, s69
  v_add_u32 v6, s68, v8
  v_lshlrev_b32 v6, 3, v6
  v_add_u32 v6, 14417920, v6
  global_load_dword v10, v6, s[34:35] sc1
  global_load_dword v11, v6, s[34:35] offset:256 sc1
  s_lshl_b32 s68, s72, 7
  s_sub_u32 s68, s68, 64
  s_lshl_b32 s68, s68, 3
  v_add_u32 v6, s68, v6
  global_load_dword v12, v6, s[34:35] sc1
  global_load_dword v13, v6, s[34:35] offset:256 sc1
  s_lshl_b32 s68, s61, 14
  s_add_u32 s68, s68, 98304
  v_lshlrev_b32 v9, 8, v8
  v_add_u32 v9, s68, v9
  v_lshrrev_b32 v6, 5, v1
  v_and_b32 v7, 7, v1
  v_xor_b32 v6, v6, v7
  v_xor_b32 v7, 0, v6
  v_lshl_add_u32 v16, v7, 4, v9
  v_xor_b32 v7, 2, v6
  v_lshl_add_u32 v17, v7, 4, v9
  v_xor_b32 v7, 4, v6
  v_lshl_add_u32 v18, v7, 4, v9
  v_xor_b32 v7, 6, v6
  v_lshl_add_u32 v19, v7, 4, v9
  v_lshrrev_b32 v6, 4, v0
  v_and_b32 v7, 15, v0
  v_lshrrev_b32 v9, 6, v0
  v_xor_b32 v9, v9, v7
  v_lshlrev_b32 v20, 8, v6
  v_lshl_add_u32 v20, v9, 4, v20
  v_xor_b32 v21, 64, v20
  v_add_u32 v22, 98304, v20
  v_add_u32 v23, 98304, v21
  s_waitcnt vmcnt(11)
  v_mfma_f32_32x32x16_bf16 v[64:79], a[0:3], a[64:67], 0
  s_waitcnt vmcnt(10)
  v_mfma_f32_32x32x16_bf16 v[80:95], a[0:3], a[68:71], 0
  v_mfma_f32_32x32x16_bf16 v[96:111], a[4:7], a[64:67], 0
  v_mfma_f32_32x32x16_bf16 v[112:127], a[4:7], a[68:71], 0
  s_add_u32 s68, s74, s52
  buffer_load_dwordx4 a[96:99], v2, s[36:39], s68 offen sc1
  buffer_load_dwordx4 a[100:103], v3, s[36:39], s68 offen sc1
  s_waitcnt vmcnt(11)
  v_mfma_f32_32x32x16_bf16 v[64:79], a[8:11], a[72:75], v[64:79]
  s_waitcnt vmcnt(10)
  v_mfma_f32_32x32x16_bf16 v[80:95], a[8:11], a[76:79], v[80:95]
  v_mfma_f32_32x32x16_bf16 v[96:111], a[12:15], a[72:75], v[96:111]
  v_mfma_f32_32x32x16_bf16 v[112:127], a[12:15], a[76:79], v[112:127]
  s_add_u32 s68, s74, s53
  buffer_load_dwordx4 a[104:107], v2, s[36:39], s68 offen sc1
  buffer_load_dwordx4 a[108:111], v3, s[36:39], s68 offen sc1
  s_waitcnt vmcnt(11)
  v_mfma_f32_32x32x16_bf16 v[64:79], a[16:19], a[80:83], v[64:79]
  s_waitcnt vmcnt(10)
  v_mfma_f32_32x32x16_bf16 v[80:95], a[16:19], a[84:87], v[80:95]
  v_mfma_f32_32x32x16_bf16 v[96:111], a[20:23], a[80:83], v[96:111]
  v_mfma_f32_32x32x16_bf16 v[112:127], a[20:23], a[84:87], v[112:127]
  s_add_u32 s68, s74, s54
  buffer_load_dwordx4 a[112:115], v2, s[36:39], s68 offen sc1
  buffer_load_dwordx4 a[116:119], v3, s[36:39], s68 offen sc1
  s_waitcnt vmcnt(11)
  v_mfma_f32_32x32x16_bf16 v[64:79], a[24:27], a[88:91], v[64:79]
  s_waitcnt vmcnt(10)
  v_mfma_f32_32x32x16_bf16 v[80:95], a[24:27], a[92:95], v[80:95]
  v_mfma_f32_32x32x16_bf16 v[96:111], a[28:31], a[88:91], v[96:111]
  v_mfma_f32_32x32x16_bf16 v[112:127], a[28:31], a[92:95], v[112:127]
  s_add_u32 s68, s74, s55
  buffer_load_dwordx4 a[120:123], v2, s[36:39], s68 offen sc1
  buffer_load_dwordx4 a[124:127], v3, s[36:39], s68 offen sc1
  s_waitcnt vmcnt(7)
  v_mfma_f32_32x32x16_bf16 v[64:79], a[32:35], a[96:99], v[64:79]
  s_waitcnt vmcnt(6)
  v_mfma_f32_32x32x16_bf16 v[80:95], a[32:35], a[100:103], v[80:95]
  v_mfma_f32_32x32x16_bf16 v[96:111], a[36:39], a[96:99], v[96:111]
  v_mfma_f32_32x32x16_bf16 v[112:127], a[36:39], a[100:103], v[112:127]
  s_waitcnt vmcnt(5)
  v_mfma_f32_32x32x16_bf16 v[64:79], a[40:43], a[104:107], v[64:79]
  s_waitcnt vmcnt(4)
  v_mfma_f32_32x32x16_bf16 v[80:95], a[40:43], a[108:111], v[80:95]
  v_mfma_f32_32x32x16_bf16 v[96:111], a[44:47], a[104:107], v[96:111]
  v_mfma_f32_32x32x16_bf16 v[112:127], a[44:47], a[108:111], v[112:127]
  s_waitcnt vmcnt(3)
  v_mfma_f32_32x32x16_bf16 v[64:79], a[48:51], a[112:115], v[64:79]
  s_waitcnt vmcnt(2)
  v_mfma_f32_32x32x16_bf16 v[80:95], a[48:51], a[116:119], v[80:95]
  v_mfma_f32_32x32x16_bf16 v[96:111], a[52:55], a[112:115], v[96:111]
  v_mfma_f32_32x32x16_bf16 v[112:127], a[52:55], a[116:119], v[112:127]
  s_waitcnt vmcnt(1)
  v_mfma_f32_32x32x16_bf16 v[64:79], a[56:59], a[120:123], v[64:79]
  s_waitcnt vmcnt(0)
  v_mfma_f32_32x32x16_bf16 v[80:95], a[56:59], a[124:127], v[80:95]
  v_mfma_f32_32x32x16_bf16 v[96:111], a[60:63], a[120:123], v[96:111]
  v_mfma_f32_32x32x16_bf16 v[112:127], a[60:63], a[124:127], v[112:127]
  s_nop 7
  v_mul_f32 v64, v10, v64
  v_mul_f32 v65, v10, v65
  v_mul_f32 v66, v10, v66
  v_mul_f32 v67, v10, v67
  v_mul_f32 v68, v10, v68
  v_mul_f32 v69, v10, v69
  v_mul_f32 v70, v10, v70
  v_mul_f32 v71, v10, v71
  v_mul_f32 v72, v10, v72
  v_mul_f32 v73, v10, v73
  v_mul_f32 v74, v10, v74
  v_mul_f32 v75, v10, v75
  v_mul_f32 v76, v10, v76
  v_mul_f32 v77, v10, v77
  v_mul_f32 v78, v10, v78
  v_mul_f32 v79, v10, v79
  ds_write_b128 v16, v[64:67] offset:0
  ds_write_b128 v17, v[68:71] offset:0
  ds_write_b128 v18, v[72:75] offset:0
  ds_write_b128 v19, v[76:79] offset:0
  v_mul_f32 v80, v11, v80
  v_mul_f32 v81, v11, v81
  v_mul_f32 v82, v11, v82
  v_mul_f32 v83, v11, v83
  v_mul_f32 v84, v11, v84
  v_mul_f32 v85, v11, v85
  v_mul_f32 v86, v11, v86
  v_mul_f32 v87, v11, v87
  v_mul_f32 v88, v11, v88
  v_mul_f32 v89, v11, v89
  v_mul_f32 v90, v11, v90
  v_mul_f32 v91, v11, v91
  v_mul_f32 v92, v11, v92
  v_mul_f32 v93, v11, v93
  v_mul_f32 v94, v11, v94
  v_mul_f32 v95, v11, v95
  ds_write_b128 v16, v[80:83] offset:8192
  ds_write_b128 v17, v[84:87] offset:8192
  ds_write_b128 v18, v[88:91] offset:8192
  ds_write_b128 v19, v[92:95] offset:8192
  v_mul_f32 v96, v10, v96
  v_mul_f32 v97, v10, v97
  v_mul_f32 v98, v10, v98
  v_mul_f32 v99, v10, v99
  v_mul_f32 v100, v10, v100
  v_mul_f32 v101, v10, v101
  v_mul_f32 v102, v10, v102
  v_mul_f32 v103, v10, v103
  v_mul_f32 v104, v10, v104
  v_mul_f32 v105, v10, v105
  v_mul_f32 v106, v10, v106
  v_mul_f32 v107, v10, v107
  v_mul_f32 v108, v10, v108
  v_mul_f32 v109, v10, v109
  v_mul_f32 v110, v10, v110
  v_mul_f32 v111, v10, v111
  ds_write_b128 v16, v[96:99] offset:128
  ds_write_b128 v17, v[100:103] offset:128
  ds_write_b128 v18, v[104:107] offset:128
  ds_write_b128 v19, v[108:111] offset:128
  v_mul_f32 v112, v11, v112
  v_mul_f32 v113, v11, v113
  v_mul_f32 v114, v11, v114
  v_mul_f32 v115, v11, v115
  v_mul_f32 v116, v11, v116
  v_mul_f32 v117, v11, v117
  v_mul_f32 v118, v11, v118
  v_mul_f32 v119, v11, v119
  v_mul_f32 v120, v11, v120
  v_mul_f32 v121, v11, v121
  v_mul_f32 v122, v11, v122
  v_mul_f32 v123, v11, v123
  v_mul_f32 v124, v11, v124
  v_mul_f32 v125, v11, v125
  v_mul_f32 v126, v11, v126
  v_mul_f32 v127, v11, v127
  ds_write_b128 v16, v[112:115] offset:8320
  ds_write_b128 v17, v[116:119] offset:8320
  ds_write_b128 v18, v[120:123] offset:8320
  ds_write_b128 v19, v[124:127] offset:8320
  s_waitcnt lgkmcnt(0)
  s_barrier
  s_add_u32 s68, s74, s48
  buffer_load_dwordx4 a[64:67], v4, s[36:39], s68 offen sc1
  buffer_load_dwordx4 a[68:71], v5, s[36:39], s68 offen sc1
  s_add_u32 s68, s74, s49
  buffer_load_dwordx4 a[72:75], v4, s[36:39], s68 offen sc1
  buffer_load_dwordx4 a[76:79], v5, s[36:39], s68 offen sc1
  s_add_u32 s68, s74, s50
  buffer_load_dwordx4 a[80:83], v4, s[36:39], s68 offen sc1
  buffer_load_dwordx4 a[84:87], v5, s[36:39], s68 offen sc1
  s_add_u32 s68, s74, s51
  buffer_load_dwordx4 a[88:91], v4, s[36:39], s68 offen sc1
  buffer_load_dwordx4 a[92:95], v5, s[36:39], s68 offen sc1
  s_add_u32 s68, s74, s52
  buffer_load_dwordx4 a[96:99], v4, s[36:39], s68 offen sc1
  buffer_load_dwordx4 a[100:103], v5, s[36:39], s68 offen sc1
  s_add_u32 s68, s74, s53
  buffer_load_dwordx4 a[104:107], v4, s[36:39], s68 offen sc1
  buffer_load_dwordx4 a[108:111], v5, s[36:39], s68 offen sc1
  s_add_u32 s68, s74, s54
  buffer_load_dwordx4 a[112:115], v4, s[36:39], s68 offen sc1
  buffer_load_dwordx4 a[116:119], v5, s[36:39], s68 offen sc1
  s_add_u32 s68, s74, s55
  buffer_load_dwordx4 a[120:123], v4, s[36:39], s68 offen sc1
  buffer_load_dwordx4 a[124:127], v5, s[36:39], s68 offen sc1
  s_waitcnt vmcnt(15)
  v_mfma_f32_32x32x16_bf16 v[64:79], a[0:3], a[64:67], 0
  s_waitcnt vmcnt(14)
  v_mfma_f32_32x32x16_bf16 v[80:95], a[0:3], a[68:71], 0
  v_mfma_f32_32x32x16_bf16 v[96:111], a[4:7], a[64:67], 0
  v_mfma_f32_32x32x16_bf16 v[112:127], a[4:7], a[68:71], 0
  s_waitcnt vmcnt(13)
  v_mfma_f32_32x32x16_bf16 v[64:79], a[8:11], a[72:75], v[64:79]
  s_waitcnt vmcnt(12)
  v_mfma_f32_32x32x16_bf16 v[80:95], a[8:11], a[76:79], v[80:95]
  v_mfma_f32_32x32x16_bf16 v[96:111], a[12:15], a[72:75], v[96:111]
  v_mfma_f32_32x32x16_bf16 v[112:127], a[12:15], a[76:79], v[112:127]
  s_waitcnt vmcnt(11)
  v_mfma_f32_32x32x16_bf16 v[64:79], a[16:19], a[80:83], v[64:79]
  s_waitcnt vmcnt(10)
  v_mfma_f32_32x32x16_bf16 v[80:95], a[16:19], a[84:87], v[80:95]
  v_mfma_f32_32x32x16_bf16 v[96:111], a[20:23], a[80:83], v[96:111]
  v_mfma_f32_32x32x16_bf16 v[112:127], a[20:23], a[84:87], v[112:127]
  s_waitcnt vmcnt(9)
  v_mfma_f32_32x32x16_bf16 v[64:79], a[24:27], a[88:91], v[64:79]
  s_waitcnt vmcnt(8)
  v_mfma_f32_32x32x16_bf16 v[80:95], a[24:27], a[92:95], v[80:95]
  v_mfma_f32_32x32x16_bf16 v[96:111], a[28:31], a[88:91], v[96:111]
  v_mfma_f32_32x32x16_bf16 v[112:127], a[28:31], a[92:95], v[112:127]
  s_waitcnt vmcnt(7)
  v_mfma_f32_32x32x16_bf16 v[64:79], a[32:35], a[96:99], v[64:79]
  s_waitcnt vmcnt(6)
  v_mfma_f32_32x32x16_bf16 v[80:95], a[32:35], a[100:103], v[80:95]
  v_mfma_f32_32x32x16_bf16 v[96:111], a[36:39], a[96:99], v[96:111]
  v_mfma_f32_32x32x16_bf16 v[112:127], a[36:39], a[100:103], v[112:127]
  s_waitcnt vmcnt(5)
  v_mfma_f32_32x32x16_bf16 v[64:79], a[40:43], a[104:107], v[64:79]
  s_waitcnt vmcnt(4)
  v_mfma_f32_32x32x16_bf16 v[80:95], a[40:43], a[108:111], v[80:95]
  v_mfma_f32_32x32x16_bf16 v[96:111], a[44:47], a[104:107], v[96:111]
  v_mfma_f32_32x32x16_bf16 v[112:127], a[44:47], a[108:111], v[112:127]
  s_waitcnt vmcnt(3)
  v_mfma_f32_32x32x16_bf16 v[64:79], a[48:51], a[112:115], v[64:79]
  s_waitcnt vmcnt(2)
  v_mfma_f32_32x32x16_bf16 v[80:95], a[48:51], a[116:119], v[80:95]
  v_mfma_f32_32x32x16_bf16 v[96:111], a[52:55], a[112:115], v[96:111]
  v_mfma_f32_32x32x16_bf16 v[112:127], a[52:55], a[116:119], v[112:127]
  s_waitcnt vmcnt(1)
  v_mfma_f32_32x32x16_bf16 v[64:79], a[56:59], a[120:123], v[64:79]
  s_waitcnt vmcnt(0)
  v_mfma_f32_32x32x16_bf16 v[80:95], a[56:59], a[124:127], v[80:95]
  v_mfma_f32_32x32x16_bf16 v[96:111], a[60:63], a[120:123], v[96:111]
  v_mfma_f32_32x32x16_bf16 v[112:127], a[60:63], a[124:127], v[112:127]
  s_barrier
  v_lshlrev_b32 v6, 4, v0
  s_lshl_b32 s68, s2, 14
  s_add_u32 s68, s68, 14827776
  v_add_u32 v6, s68, v6
  ds_read_b128 v[24:27], v20 offset:0
  ds_read_b128 v[28:31], v20 offset:16384
  ds_read_b128 v[32:35], v20 offset:32768
  ds_read_b128 v[36:39], v20 offset:49152
  ds_read_b128 v[40:43], v22 offset:0
  ds_read_b128 v[44:47], v22 offset:16384
  ds_read_b128 v[48:51], v22 offset:32768
  ds_read_b128 v[52:55], v22 offset:49152
  s_waitcnt lgkmcnt(6)
  v_add_f32 v24, v24, v28
  v_add_f32 v25, v25, v29
  v_add_f32 v26, v26, v30
  v_add_f32 v27, v27, v31
  s_waitcnt lgkmcnt(4)
  v_add_f32 v32, v32, v36
  v_add_f32 v33, v33, v37
  v_add_f32 v34, v34, v38
  v_add_f32 v35, v35, v39
  s_waitcnt lgkmcnt(2)
  v_add_f32 v40, v40, v44
  v_add_f32 v41, v41, v45
  v_add_f32 v42, v42, v46
  v_add_f32 v43, v43, v47
  s_waitcnt lgkmcnt(0)
  v_add_f32 v48, v48, v52
  v_add_f32 v49, v49, v53
  v_add_f32 v50, v50, v54
  v_add_f32 v51, v51, v55
  v_add_f32 v24, v24, v32
  v_add_f32 v25, v25, v33
  v_add_f32 v26, v26, v34
  v_add_f32 v27, v27, v35
  v_add_f32 v40, v40, v48
  v_add_f32 v41, v41, v49
  v_add_f32 v42, v42, v50
  v_add_f32 v43, v43, v51
  v_add_f32 v56, v24, v40
  v_add_f32 v57, v25, v41
  v_add_f32 v58, v26, v42
  v_add_f32 v59, v27, v43
  v_and_or_b32 v56, v56, -16, s84
  v_and_or_b32 v57, v57, -16, s85
  v_and_or_b32 v58, v58, -16, s86
  v_and_or_b32 v59, v59, -16, s87
  global_store_dwordx4 v6, v[56:59], s[34:35] sc0 sc1
  ds_read_b128 v[24:27], v21 offset:4096
  ds_read_b128 v[28:31], v21 offset:20480
  ds_read_b128 v[32:35], v21 offset:36864
  ds_read_b128 v[36:39], v21 offset:53248
  ds_read_b128 v[40:43], v23 offset:4096
  ds_read_b128 v[44:47], v23 offset:20480
  ds_read_b128 v[48:51], v23 offset:36864
  ds_read_b128 v[52:55], v23 offset:53248
  s_waitcnt lgkmcnt(6)
  v_add_f32 v24, v24, v28
  v_add_f32 v25, v25, v29
  v_add_f32 v26, v26, v30
  v_add_f32 v27, v27, v31
  s_waitcnt lgkmcnt(4)
  v_add_f32 v32, v32, v36
  v_add_f32 v33, v33, v37
  v_add_f32 v34, v34, v38
  v_add_f32 v35, v35, v39
  s_waitcnt lgkmcnt(2)
  v_add_f32 v40, v40, v44
  v_add_f32 v41, v41, v45
  v_add_f32 v42, v42, v46
  v_add_f32 v43, v43, v47
  s_waitcnt lgkmcnt(0)
  v_add_f32 v48, v48, v52
  v_add_f32 v49, v49, v53
  v_add_f32 v50, v50, v54
  v_add_f32 v51, v51, v55
  v_add_f32 v24, v24, v32
  v_add_f32 v25, v25, v33
  v_add_f32 v26, v26, v34
  v_add_f32 v27, v27, v35
  v_add_f32 v40, v40, v48
  v_add_f32 v41, v41, v49
  v_add_f32 v42, v42, v50
  v_add_f32 v43, v43, v51
  v_add_f32 v60, v24, v40
  v_add_f32 v61, v25, v41
  v_add_f32 v62, v26, v42
  v_add_f32 v63, v27, v43
  v_and_or_b32 v60, v60, -16, s84
  v_and_or_b32 v61, v61, -16, s85
  v_and_or_b32 v62, v62, -16, s86
  v_and_or_b32 v63, v63, -16, s87
  v_add_u32 v6, 4096, v6
  global_store_dwordx4 v6, v[60:63], s[34:35] sc0 sc1
  ds_read_b128 v[24:27], v20 offset:8192
  ds_read_b128 v[28:31], v20 offset:24576
  ds_read_b128 v[32:35], v20 offset:40960
  ds_read_b128 v[36:39], v20 offset:57344
  ds_read_b128 v[40:43], v22 offset:8192
  ds_read_b128 v[44:47], v22 offset:24576
  ds_read_b128 v[48:51], v22 offset:40960
  ds_read_b128 v[52:55], v22 offset:57344
  s_waitcnt lgkmcnt(6)
  v_add_f32 v24, v24, v28
  v_add_f32 v25, v25, v29
  v_add_f32 v26, v26, v30
  v_add_f32 v27, v27, v31
  s_waitcnt lgkmcnt(4)
  v_add_f32 v32, v32, v36
  v_add_f32 v33, v33, v37
  v_add_f32 v34, v34, v38
  v_add_f32 v35, v35, v39
  s_waitcnt lgkmcnt(2)
  v_add_f32 v40, v40, v44
  v_add_f32 v41, v41, v45
  v_add_f32 v42, v42, v46
  v_add_f32 v43, v43, v47
  s_waitcnt lgkmcnt(0)
  v_add_f32 v48, v48, v52
  v_add_f32 v49, v49, v53
  v_add_f32 v50, v50, v54
  v_add_f32 v51, v51, v55
  v_add_f32 v24, v24, v32
  v_add_f32 v25, v25, v33
  v_add_f32 v26, v26, v34
  v_add_f32 v27, v27, v35
  v_add_f32 v40, v40, v48
  v_add_f32 v41, v41, v49
  v_add_f32 v42, v42, v50
  v_add_f32 v43, v43, v51
  v_add_f32 v56, v24, v40
  v_add_f32 v57, v25, v41
  v_add_f32 v58, v26, v42
  v_add_f32 v59, v27, v43
  v_and_or_b32 v56, v56, -16, s84
  v_and_or_b32 v57, v57, -16, s85
  v_and_or_b32 v58, v58, -16, s86
  v_and_or_b32 v59, v59, -16, s87
  v_add_u32 v6, 4096, v6
  global_store_dwordx4 v6, v[56:59], s[34:35] sc0 sc1
  ds_read_b128 v[24:27], v21 offset:12288
  ds_read_b128 v[28:31], v21 offset:28672
  ds_read_b128 v[32:35], v21 offset:45056
  ds_read_b128 v[36:39], v21 offset:61440
  ds_read_b128 v[40:43], v23 offset:12288
  ds_read_b128 v[44:47], v23 offset:28672
  ds_read_b128 v[48:51], v23 offset:45056
  ds_read_b128 v[52:55], v23 offset:61440
  s_waitcnt lgkmcnt(6)
  v_add_f32 v24, v24, v28
  v_add_f32 v25, v25, v29
  v_add_f32 v26, v26, v30
  v_add_f32 v27, v27, v31
  s_waitcnt lgkmcnt(4)
  v_add_f32 v32, v32, v36
  v_add_f32 v33, v33, v37
  v_add_f32 v34, v34, v38
  v_add_f32 v35, v35, v39
  s_waitcnt lgkmcnt(2)
  v_add_f32 v40, v40, v44
  v_add_f32 v41, v41, v45
  v_add_f32 v42, v42, v46
  v_add_f32 v43, v43, v47
  s_waitcnt lgkmcnt(0)
  v_add_f32 v48, v48, v52
  v_add_f32 v49, v49, v53
  v_add_f32 v50, v50, v54
  v_add_f32 v51, v51, v55
  v_add_f32 v24, v24, v32
  v_add_f32 v25, v25, v33
  v_add_f32 v26, v26, v34
  v_add_f32 v27, v27, v35
  v_add_f32 v40, v40, v48
  v_add_f32 v41, v41, v49
  v_add_f32 v42, v42, v50
  v_add_f32 v43, v43, v51
  v_add_f32 v60, v24, v40
  v_add_f32 v61, v25, v41
  v_add_f32 v62, v26, v42
  v_add_f32 v63, v27, v43
  v_and_or_b32 v60, v60, -16, s84
  v_and_or_b32 v61, v61, -16, s85
  v_and_or_b32 v62, v62, -16, s86
  v_and_or_b32 v63, v63, -16, s87
  v_add_u32 v6, 4096, v6
  global_store_dwordx4 v6, v[60:63], s[34:35] sc0 sc1
  s_barrier
  v_mul_f32 v64, v12, v64
  v_mul_f32 v65, v12, v65
  v_mul_f32 v66, v12, v66
  v_mul_f32 v67, v12, v67
  v_mul_f32 v68, v12, v68
  v_mul_f32 v69, v12, v69
  v_mul_f32 v70, v12, v70
  v_mul_f32 v71, v12, v71
  v_mul_f32 v72, v12, v72
  v_mul_f32 v73, v12, v73
  v_mul_f32 v74, v12, v74
  v_mul_f32 v75, v12, v75
  v_mul_f32 v76, v12, v76
  v_mul_f32 v77, v12, v77
  v_mul_f32 v78, v12, v78
  v_mul_f32 v79, v12, v79
  ds_write_b128 v16, v[64:67] offset:0
  ds_write_b128 v17, v[68:71] offset:0
  ds_write_b128 v18, v[72:75] offset:0
  ds_write_b128 v19, v[76:79] offset:0
  v_mul_f32 v80, v13, v80
  v_mul_f32 v81, v13, v81
  v_mul_f32 v82, v13, v82
  v_mul_f32 v83, v13, v83
  v_mul_f32 v84, v13, v84
  v_mul_f32 v85, v13, v85
  v_mul_f32 v86, v13, v86
  v_mul_f32 v87, v13, v87
  v_mul_f32 v88, v13, v88
  v_mul_f32 v89, v13, v89
  v_mul_f32 v90, v13, v90
  v_mul_f32 v91, v13, v91
  v_mul_f32 v92, v13, v92
  v_mul_f32 v93, v13, v93
  v_mul_f32 v94, v13, v94
  v_mul_f32 v95, v13, v95
  ds_write_b128 v16, v[80:83] offset:8192
  ds_write_b128 v17, v[84:87] offset:8192
  ds_write_b128 v18, v[88:91] offset:8192
  ds_write_b128 v19, v[92:95] offset:8192
  v_mul_f32 v96, v12, v96
  v_mul_f32 v97, v12, v97
  v_mul_f32 v98, v12, v98
  v_mul_f32 v99, v12, v99
  v_mul_f32 v100, v12, v100
  v_mul_f32 v101, v12, v101
  v_mul_f32 v102, v12, v102
  v_mul_f32 v103, v12, v103
  v_mul_f32 v104, v12, v104
  v_mul_f32 v105, v12, v105
  v_mul_f32 v106, v12, v106
  v_mul_f32 v107, v12, v107
  v_mul_f32 v108, v12, v108
  v_mul_f32 v109, v12, v109
  v_mul_f32 v110, v12, v110
  v_mul_f32 v111, v12, v111
  ds_write_b128 v16, v[96:99] offset:128
  ds_write_b128 v17, v[100:103] offset:128
  ds_write_b128 v18, v[104:107] offset:128
  ds_write_b128 v19, v[108:111] offset:128
  v_mul_f32 v112, v13, v112
  v_mul_f32 v113, v13, v113
  v_mul_f32 v114, v13, v114
  v_mul_f32 v115, v13, v115
  v_mul_f32 v116, v13, v116
  v_mul_f32 v117, v13, v117
  v_mul_f32 v118, v13, v118
  v_mul_f32 v119, v13, v119
  v_mul_f32 v120, v13, v120
  v_mul_f32 v121, v13, v121
  v_mul_f32 v122, v13, v122
  v_mul_f32 v123, v13, v123
  v_mul_f32 v124, v13, v124
  v_mul_f32 v125, v13, v125
  v_mul_f32 v126, v13, v126
  v_mul_f32 v127, v13, v127
  ds_write_b128 v16, v[112:115] offset:8320
  ds_write_b128 v17, v[116:119] offset:8320
  ds_write_b128 v18, v[120:123] offset:8320
  ds_write_b128 v19, v[124:127] offset:8320
  s_waitcnt lgkmcnt(0)
  v_lshlrev_b32 v6, 4, v0
  s_xor_b32 s69, s2, 1
  s_lshl_b32 s68, s69, 14
  s_add_u32 s68, s68, 14827776
  v_add_u32 v9, s68, v6
  global_load_dwordx4 v[64:67], v9, s[34:35] sc1
  v_add_u32 v7, 4096, v9
  global_load_dwordx4 v[68:71], v7, s[34:35] sc1
  v_add_u32 v7, 8192, v9
  global_load_dwordx4 v[72:75], v7, s[34:35] sc1
  v_add_u32 v7, 12288, v9
  global_load_dwordx4 v[76:79], v7, s[34:35] sc1
  v_lshrrev_b32 v6, 4, v0
  v_and_b32 v8, 15, v0
  s_lshl_b32 s68, s62, 7
  s_lshl_b32 s69, s72, 6
  s_add_u32 s68, s68, s69
  v_add_u32 v6, s68, v6
  s_lshl_b32 s69, s73, 7
  v_lshlrev_b32 v2, 10, v6
  v_lshl_add_u32 v2, v8, 3, v2
  v_add_u32 v2, s69, v2
  global_load_dwordx2 v[96:97], v2, s[4:5]
  v_add_u32 v2, 16384, v2
  global_load_dwordx2 v[98:99], v2, s[4:5]
  v_add_u32 v2, 16384, v2
  global_load_dwordx2 v[100:101], v2, s[4:5]
  v_add_u32 v2, 16384, v2
  global_load_dwordx2 v[102:103], v2, s[4:5]
  v_lshlrev_b32 v2, 3, v8
  v_add_u32 v2, s69, v2
  global_load_dwordx2 v[104:105], v2, s[20:21]
  v_lshlrev_b32 v2, 3, v6
  v_add_u32 v2, 14417920, v2
  global_load_dword v106, v2, s[34:35] offset:0 sc1
  global_load_dword v107, v2, s[34:35] offset:128 sc1
  global_load_dword v108, v2, s[34:35] offset:256 sc1
  global_load_dword v109, v2, s[34:35] offset:384 sc1
  s_lshl_b32 s69, s73, 8
  v_lshlrev_b32 v2, 11, v6
  v_lshl_add_u32 v2, v8, 4, v2
  v_add_u32 v2, s69, v2
  s_waitcnt vmcnt(4)
  v_lshlrev_b32 v110, 16, v104
  v_and_b32 v111, 0xffff0000, v104
  v_lshlrev_b32 v112, 16, v105
  v_and_b32 v113, 0xffff0000, v105
  v_lshlrev_b32 v80, 16, v96
  v_and_b32 v81, 0xffff0000, v96
  v_lshlrev_b32 v82, 16, v97
  v_and_b32 v83, 0xffff0000, v97
  v_mul_f32 v80, v80, v110
  v_mul_f32 v81, v81, v111
  v_mul_f32 v82, v82, v112
  v_mul_f32 v83, v83, v113
  v_cvt_pk_bf16_f32 v56, v80, v81
  v_cvt_pk_bf16_f32 v57, v82, v83
  v_lshlrev_b32 v80, 16, v56
  v_and_b32 v81, 0xffff0000, v56
  v_lshlrev_b32 v82, 16, v57
  v_and_b32 v83, 0xffff0000, v57
  s_waitcnt vmcnt(3)
  v_mul_f32 v80, v106, v80
  v_mul_f32 v81, v106, v81
  v_mul_f32 v82, v106, v82
  v_mul_f32 v83, v106, v83
  v_lshlrev_b32 v84, 16, v98
  v_and_b32 v85, 0xffff0000, v98
  v_lshlrev_b32 v86, 16, v99
  v_and_b32 v87, 0xffff0000, v99
  v_mul_f32 v84, v84, v110
  v_mul_f32 v85, v85, v111
  v_mul_f32 v86, v86, v112
  v_mul_f32 v87, v87, v113
  v_cvt_pk_bf16_f32 v56, v84, v85
  v_cvt_pk_bf16_f32 v57, v86, v87
  v_lshlrev_b32 v84, 16, v56
  v_and_b32 v85, 0xffff0000, v56
  v_lshlrev_b32 v86, 16, v57
  v_and_b32 v87, 0xffff0000, v57
  s_waitcnt vmcnt(2)
  v_mul_f32 v84, v107, v84
  v_mul_f32 v85, v107, v85
  v_mul_f32 v86, v107, v86
  v_mul_f32 v87, v107, v87
  v_lshlrev_b32 v88, 16, v100
  v_and_b32 v89, 0xffff0000, v100
  v_lshlrev_b32 v90, 16, v101
  v_and_b32 v91, 0xffff0000, v101
  v_mul_f32 v88, v88, v110
  v_mul_f32 v89, v89, v111
  v_mul_f32 v90, v90, v112
  v_mul_f32 v91, v91, v113
  v_cvt_pk_bf16_f32 v56, v88, v89
  v_cvt_pk_bf16_f32 v57, v90, v91
  v_lshlrev_b32 v88, 16, v56
  v_and_b32 v89, 0xffff0000, v56
  v_lshlrev_b32 v90, 16, v57
  v_and_b32 v91, 0xffff0000, v57
  s_waitcnt vmcnt(1)
  v_mul_f32 v88, v108, v88
  v_mul_f32 v89, v108, v89
  v_mul_f32 v90, v108, v90
  v_mul_f32 v91, v108, v91
  v_lshlrev_b32 v92, 16, v102
  v_and_b32 v93, 0xffff0000, v102
  v_lshlrev_b32 v94, 16, v103
  v_and_b32 v95, 0xffff0000, v103
  v_mul_f32 v92, v92, v110
  v_mul_f32 v93, v93, v111
  v_mul_f32 v94, v94, v112
  v_mul_f32 v95, v95, v113
  v_cvt_pk_bf16_f32 v56, v92, v93
  v_cvt_pk_bf16_f32 v57, v94, v95
  v_lshlrev_b32 v92, 16, v56
  v_and_b32 v93, 0xffff0000, v56
  v_lshlrev_b32 v94, 16, v57
  v_and_b32 v95, 0xffff0000, v57
  s_waitcnt vmcnt(0)
  v_mul_f32 v92, v109, v92
  v_mul_f32 v93, v109, v93
  v_mul_f32 v94, v109, v94
  v_mul_f32 v95, v109, v95
  s_mov_b32 s98, 0
L_p2_chk:
  v_mov_b32 v58, 0
  v_xor_b32 v64, s84, v64
  v_and_or_b32 v58, v64, 15, v58
  v_xor_b32 v65, s85, v65
  v_and_or_b32 v58, v65, 15, v58
  v_xor_b32 v66, s86, v66
  v_and_or_b32 v58, v66, 15, v58
  v_xor_b32 v67, s87, v67
  v_and_or_b32 v58, v67, 15, v58
  v_xor_b32 v68, s84, v68
  v_and_or_b32 v58, v68, 15, v58
  v_xor_b32 v69, s85, v69
  v_and_or_b32 v58, v69, 15, v58
  v_xor_b32 v70, s86, v70
  v_and_or_b32 v58, v70, 15, v58
  v_xor_b32 v71, s87, v71
  v_and_or_b32 v58, v71, 15, v58
  v_xor_b32 v72, s84, v72
  v_and_or_b32 v58, v72, 15, v58
  v_xor_b32 v73, s85, v73
  v_and_or_b32 v58, v73, 15, v58
  v_xor_b32 v74, s86, v74
  v_and_or_b32 v58, v74, 15, v58
  v_xor_b32 v75, s87, v75
  v_and_or_b32 v58, v75, 15, v58
  v_xor_b32 v76, s84, v76
  v_and_or_b32 v58, v76, 15, v58
  v_xor_b32 v77, s85, v77
  v_and_or_b32 v58, v77, 15, v58
  v_xor_b32 v78, s86, v78
  v_and_or_b32 v58, v78, 15, v58
  v_xor_b32 v79, s87, v79
  v_and_or_b32 v58, v79, 15, v58
  v_cmp_eq_u32 vcc, 0, v58
  s_nop 0
  s_cmp_eq_u64 vcc, -1
  s_cbranch_scc1 L_p2_ok
  s_add_u32 s98, s98, 1
  s_cmp_gt_u32 s98, 100000
  s_cbranch_scc1 L_p2_ok
  global_load_dwordx4 v[64:67], v9, s[34:35] sc1
  v_add_u32 v7, 4096, v9
  global_load_dwordx4 v[68:71], v7, s[34:35] sc1
  v_add_u32 v7, 8192, v9
  global_load_dwordx4 v[72:75], v7, s[34:35] sc1
  v_add_u32 v7, 12288, v9
  global_load_dwordx4 v[76:79], v7, s[34:35] sc1
  s_waitcnt vmcnt(0)
  s_branch L_p2_chk
L_p2_ok:
  v_add_f32 v80, v80, v64
  v_add_f32 v81, v81, v65
  v_add_f32 v82, v82, v66
  v_add_f32 v83, v83, v67
  v_add_f32 v84, v84, v68
  v_add_f32 v85, v85, v69
  v_add_f32 v86, v86, v70
  v_add_f32 v87, v87, v71
  v_add_f32 v88, v88, v72
  v_add_f32 v89, v89, v73
  v_add_f32 v90, v90, v74
  v_add_f32 v91, v91, v75
  v_add_f32 v92, v92, v76
  v_add_f32 v93, v93, v77
  v_add_f32 v94, v94, v78
  v_add_f32 v95, v95, v79
  s_barrier
  ds_read_b128 v[24:27], v20 offset:0
  ds_read_b128 v[28:31], v20 offset:16384
  ds_read_b128 v[32:35], v20 offset:32768
  ds_read_b128 v[36:39], v20 offset:49152
  ds_read_b128 v[40:43], v22 offset:0
  ds_read_b128 v[44:47], v22 offset:16384
  ds_read_b128 v[48:51], v22 offset:32768
  ds_read_b128 v[52:55], v22 offset:49152
  s_waitcnt lgkmcnt(6)
  v_pk_add_f32 v[24:25], v[24:25], v[28:29]
  v_pk_add_f32 v[26:27], v[26:27], v[30:31]
  s_waitcnt lgkmcnt(4)
  v_pk_add_f32 v[32:33], v[32:33], v[36:37]
  v_pk_add_f32 v[34:35], v[34:35], v[38:39]
  s_waitcnt lgkmcnt(2)
  v_pk_add_f32 v[40:41], v[40:41], v[44:45]
  v_pk_add_f32 v[42:43], v[42:43], v[46:47]
  s_waitcnt lgkmcnt(0)
  v_pk_add_f32 v[48:49], v[48:49], v[52:53]
  v_pk_add_f32 v[50:51], v[50:51], v[54:55]
  v_pk_add_f32 v[24:25], v[24:25], v[32:33]
  v_pk_add_f32 v[26:27], v[26:27], v[34:35]
  v_pk_add_f32 v[40:41], v[40:41], v[48:49]
  v_pk_add_f32 v[42:43], v[42:43], v[50:51]
  v_pk_add_f32 v[56:57], v[24:25], v[40:41]
  v_pk_add_f32 v[58:59], v[26:27], v[42:43]
  v_pk_add_f32 v[56:57], v[56:57], v[80:81]
  v_pk_add_f32 v[58:59], v[58:59], v[82:83]
  global_store_dwordx4 v2, v[56:59], s[30:31] sc0 sc1
  ds_read_b128 v[24:27], v21 offset:4096
  ds_read_b128 v[28:31], v21 offset:20480
  ds_read_b128 v[32:35], v21 offset:36864
  ds_read_b128 v[36:39], v21 offset:53248
  ds_read_b128 v[40:43], v23 offset:4096
  ds_read_b128 v[44:47], v23 offset:20480
  ds_read_b128 v[48:51], v23 offset:36864
  ds_read_b128 v[52:55], v23 offset:53248
  s_waitcnt lgkmcnt(6)
  v_pk_add_f32 v[24:25], v[24:25], v[28:29]
  v_pk_add_f32 v[26:27], v[26:27], v[30:31]
  s_waitcnt lgkmcnt(4)
  v_pk_add_f32 v[32:33], v[32:33], v[36:37]
  v_pk_add_f32 v[34:35], v[34:35], v[38:39]
  s_waitcnt lgkmcnt(2)
  v_pk_add_f32 v[40:41], v[40:41], v[44:45]
  v_pk_add_f32 v[42:43], v[42:43], v[46:47]
  s_waitcnt lgkmcnt(0)
  v_pk_add_f32 v[48:49], v[48:49], v[52:53]
  v_pk_add_f32 v[50:51], v[50:51], v[54:55]
  v_pk_add_f32 v[24:25], v[24:25], v[32:33]
  v_pk_add_f32 v[26:27], v[26:27], v[34:35]
  v_pk_add_f32 v[40:41], v[40:41], v[48:49]
  v_pk_add_f32 v[42:43], v[42:43], v[50:51]
  v_pk_add_f32 v[60:61], v[24:25], v[40:41]
  v_pk_add_f32 v[62:63], v[26:27], v[42:43]
  v_pk_add_f32 v[60:61], v[60:61], v[84:85]
  v_pk_add_f32 v[62:63], v[62:63], v[86:87]
  v_add_u32 v2, 32768, v2
  global_store_dwordx4 v2, v[60:63], s[30:31] sc0 sc1
  ds_read_b128 v[24:27], v20 offset:8192
  ds_read_b128 v[28:31], v20 offset:24576
  ds_read_b128 v[32:35], v20 offset:40960
  ds_read_b128 v[36:39], v20 offset:57344
  ds_read_b128 v[40:43], v22 offset:8192
  ds_read_b128 v[44:47], v22 offset:24576
  ds_read_b128 v[48:51], v22 offset:40960
  ds_read_b128 v[52:55], v22 offset:57344
  s_waitcnt lgkmcnt(6)
  v_pk_add_f32 v[24:25], v[24:25], v[28:29]
  v_pk_add_f32 v[26:27], v[26:27], v[30:31]
  s_waitcnt lgkmcnt(4)
  v_pk_add_f32 v[32:33], v[32:33], v[36:37]
  v_pk_add_f32 v[34:35], v[34:35], v[38:39]
  s_waitcnt lgkmcnt(2)
  v_pk_add_f32 v[40:41], v[40:41], v[44:45]
  v_pk_add_f32 v[42:43], v[42:43], v[46:47]
  s_waitcnt lgkmcnt(0)
  v_pk_add_f32 v[48:49], v[48:49], v[52:53]
  v_pk_add_f32 v[50:51], v[50:51], v[54:55]
  v_pk_add_f32 v[24:25], v[24:25], v[32:33]
  v_pk_add_f32 v[26:27], v[26:27], v[34:35]
  v_pk_add_f32 v[40:41], v[40:41], v[48:49]
  v_pk_add_f32 v[42:43], v[42:43], v[50:51]
  v_pk_add_f32 v[56:57], v[24:25], v[40:41]
  v_pk_add_f32 v[58:59], v[26:27], v[42:43]
  v_pk_add_f32 v[56:57], v[56:57], v[88:89]
  v_pk_add_f32 v[58:59], v[58:59], v[90:91]
  v_add_u32 v2, 32768, v2
  global_store_dwordx4 v2, v[56:59], s[30:31] sc0 sc1
  ds_read_b128 v[24:27], v21 offset:12288
  ds_read_b128 v[28:31], v21 offset:28672
  ds_read_b128 v[32:35], v21 offset:45056
  ds_read_b128 v[36:39], v21 offset:61440
  ds_read_b128 v[40:43], v23 offset:12288
  ds_read_b128 v[44:47], v23 offset:28672
  ds_read_b128 v[48:51], v23 offset:45056
  ds_read_b128 v[52:55], v23 offset:61440
  s_waitcnt lgkmcnt(6)
  v_pk_add_f32 v[24:25], v[24:25], v[28:29]
  v_pk_add_f32 v[26:27], v[26:27], v[30:31]
  s_waitcnt lgkmcnt(4)
  v_pk_add_f32 v[32:33], v[32:33], v[36:37]
  v_pk_add_f32 v[34:35], v[34:35], v[38:39]
  s_waitcnt lgkmcnt(2)
  v_pk_add_f32 v[40:41], v[40:41], v[44:45]
  v_pk_add_f32 v[42:43], v[42:43], v[46:47]
  s_waitcnt lgkmcnt(0)
  v_pk_add_f32 v[48:49], v[48:49], v[52:53]
  v_pk_add_f32 v[50:51], v[50:51], v[54:55]
  v_pk_add_f32 v[24:25], v[24:25], v[32:33]
  v_pk_add_f32 v[26:27], v[26:27], v[34:35]
  v_pk_add_f32 v[40:41], v[40:41], v[48:49]
  v_pk_add_f32 v[42:43], v[42:43], v[50:51]
  v_pk_add_f32 v[60:61], v[24:25], v[40:41]
  v_pk_add_f32 v[62:63], v[26:27], v[42:43]
  v_pk_add_f32 v[60:61], v[60:61], v[92:93]
  v_pk_add_f32 v[62:63], v[62:63], v[94:95]
  v_add_u32 v2, 32768, v2
  global_store_dwordx4 v2, v[60:63], s[30:31] sc0 sc1
  s_endpgm
L_k1_F:
  s_cmp_ge_u32 s63, 14
  s_cbranch_scc1 L_k1_Fn
  s_add_u32 s90, s56, 0
  s_and_b32 s90, s90, 7
  s_lshl_b32 s90, s90, 7
  s_add_u32 s91, s56, 1
  s_and_b32 s91, s91, 7
  s_lshl_b32 s91, s91, 7
  s_add_u32 s92, s56, 2
  s_and_b32 s92, s92, 7
  s_lshl_b32 s92, s92, 7
  s_add_u32 s93, s56, 3
  s_and_b32 s93, s93, 7
  s_lshl_b32 s93, s93, 7
  s_add_u32 s94, s56, 4
  s_and_b32 s94, s94, 7
  s_lshl_b32 s94, s94, 7
  s_add_u32 s95, s56, 5
  s_and_b32 s95, s95, 7
  s_lshl_b32 s95, s95, 7
  s_add_u32 s96, s56, 6
  s_and_b32 s96, s96, 7
  s_lshl_b32 s96, s96, 7
  s_add_u32 s97, s56, 7
  s_and_b32 s97, s97, 7
  s_lshl_b32 s97, s97, 7
  v_and_b32 v20, 7, v1
  v_lshrrev_b32 v21, 4, v1
  v_xor_b32 v22, v20, v21
  v_lshlrev_b32 v22, 4, v22
  v_lshrrev_b32 v23, 3, v1
  s_lshl_b32 s68, s62, 17
  s_lshl_b32 s69, s61, 15
  s_add_u32 s68, s68, s69
  v_lshlrev_b32 v20, 12, v23
  v_add3_u32 v2, v20, v22, s68
  v_xor_b32 v3, 64, v2
  s_and_b32 s68, s61, 1
  s_lshl_b32 s68, s68, 6
  v_xor_b32 v21, s68, v22
  s_lshl_b32 s68, s61, 13
  s_lshl_b32 s69, s63, 15
  s_add_u32 s68, s68, s69
  v_lshlrev_b32 v20, 10, v23
  v_add3_u32 v4, v20, v21, s68
  s_waitcnt lgkmcnt(0)
  s_mov_b32 s36, s4
  s_mov_b32 s37, s5
  s_mov_b32 s38, 2097152
  s_mov_b32 s39, 0x20000
  s_mov_b32 s40, s10
  s_mov_b32 s41, s11
  s_mov_b32 s42, 524288
  s_mov_b32 s43, 0x20000
  s_sub_u32 s44, s12, 1024
  s_subb_u32 s45, s13, 0
  s_mov_b32 s46, 525312
  s_mov_b32 s47, 0x20000
  s_add_u32 m0, s64, 0
  s_nop 0
  buffer_load_dwordx4 v2, s[36:39], s90 offen lds
  buffer_load_dwordx4 v3, s[36:39], s90 offen offset:1024 lds
  buffer_load_dwordx4 v2, s[36:39], s90 offen offset:2048 lds
  buffer_load_dwordx4 v3, s[36:39], s90 offen offset:3072 lds
  s_add_u32 m0, s65, 16384
  s_nop 0
  buffer_load_dwordx4 v4, s[40:43], s90 offen lds
  buffer_load_dwordx4 v4, s[44:47], s90 offen offset:1024 lds
  s_add_u32 m0, s64, 24576
  s_nop 0
  buffer_load_dwordx4 v2, s[36:39], s91 offen lds
  buffer_load_dwordx4 v3, s[36:39], s91 offen offset:1024 lds
  buffer_load_dwordx4 v2, s[36:39], s91 offen offset:2048 lds
  buffer_load_dwordx4 v3, s[36:39], s91 offen offset:3072 lds
  s_add_u32 m0, s65, 40960
  s_nop 0
  buffer_load_dwordx4 v4, s[40:43], s91 offen lds
  buffer_load_dwordx4 v4, s[44:47], s91 offen offset:1024 lds
  s_add_u32 m0, s64, 49152
  s_nop 0
  buffer_load_dwordx4 v2, s[36:39], s92 offen lds
  buffer_load_dwordx4 v3, s[36:39], s92 offen offset:1024 lds
  buffer_load_dwordx4 v2, s[36:39], s92 offen offset:2048 lds
  buffer_load_dwordx4 v3, s[36:39], s92 offen offset:3072 lds
  s_add_u32 m0, s65, 65536
  s_nop 0
  buffer_load_dwordx4 v4, s[40:43], s92 offen lds
  buffer_load_dwordx4 v4, s[44:47], s92 offen offset:1024 lds
  s_mov_b32 s52, s34
  s_mov_b32 s53, s35
  s_mov_b32 s54, 19022080
  s_mov_b32 s55, 0x20000
  s_mov_b32 s48, s24
  s_mov_b32 s49, s25
  s_mov_b32 s50, 1835008
  s_mov_b32 s51, 0x20000
  v_bfe_u32 v21, v1, 4, 1
  v_lshlrev_b32 v21, 2, v21
  v_and_b32 v23, 7, v1
  v_xor_b32 v23, v23, v21
  v_lshlrev_b32 v23, 4, v23
  v_lshrrev_b32 v21, 3, v1
  s_lshl_b32 s71, s61, 4
  v_add_u32 v21, s71, v21
  v_mul_u32_u24 v21, 3584, v21
  v_add_u32 v5, v21, v23
  v_add_u32 v6, 27648, v5
  s_lshl_b32 s71, s63, 8
  s_mul_i32 s72, s90, 1792
  s_add_u32 s72, s72, s71
  s_mul_i32 s73, s91, 1792
  s_add_u32 s73, s73, s71
  s_mul_i32 s74, s92, 1792
  s_add_u32 s74, s74, s71
  s_mul_i32 s75, s93, 1792
  s_add_u32 s75, s75, s71
  s_mul_i32 s76, s94, 1792
  s_add_u32 s76, s76, s71
  s_mul_i32 s77, s95, 1792
  s_add_u32 s77, s77, s71
  s_mul_i32 s78, s96, 1792
  s_add_u32 s78, s78, s71
  s_mul_i32 s79, s97, 1792
  s_add_u32 s79, s79, s71
  v_lshrrev_b32 v20, 5, v1
  v_mul_u32_u24 v20, 8, v20
  v_bfe_u32 v21, v1, 2, 2
  v_add_u32 v20, v20, v21
  v_lshlrev_b32 v20, 7, v20
  v_bfe_u32 v21, v1, 3, 1
  v_lshlrev_b32 v21, 6, v21
  v_bfe_u32 v22, v1, 4, 1
  v_lshlrev_b32 v22, 5, v22
  v_and_b32 v23, 3, v1
  v_lshlrev_b32 v23, 3, v23
  v_add3_u32 v20, v20, v22, v23
  v_add_u32 v12, v20, v21
  v_xor_b32 v21, 64, v21
  v_add_u32 v13, v20, v21
  v_add_u32 v16, 0x10000, v12
  v_add_u32 v17, 0x10000, v13
  v_add_u32 v18, 0x20000, v12
  v_add_u32 v19, 0x20000, v13
  v_lshlrev_b32 v7, 4, v1
  v_and_b32 v20, 31, v1
  v_lshrrev_b32 v21, 5, v1
  v_bfe_u32 v22, v1, 1, 3
  v_xor_b32 v22, v21, v22
  v_lshlrev_b32 v21, 7, v20
  v_add_u32 v21, s64, v21
  v_xor_b32 v23, 0, v22
  v_lshl_add_u32 v8, v23, 4, v21
  v_xor_b32 v23, 2, v22
  v_lshl_add_u32 v9, v23, 4, v21
  v_xor_b32 v23, 4, v22
  v_lshl_add_u32 v10, v23, 4, v21
  v_xor_b32 v23, 6, v22
  v_lshl_add_u32 v11, v23, 4, v21
  s_mov_b32 s66, 0xbfb8aa3b
  s_mov_b32 s67, 0xbfb8aa3b
  s_lshl_b32 s99, s63, 13
  s_add_u32 s99, s99, s86
  s_add_u32 s99, s99, 65536
  s_waitcnt vmcnt(12)
  s_waitcnt lgkmcnt(0)
  s_barrier
  ds_read_b128 a[0:3], v8 offset:0
  ds_read_b128 a[4:7], v9 offset:0
  ds_read_b128 a[8:11], v10 offset:0
  ds_read_b128 a[12:15], v11 offset:0
  s_add_u32 m0, s64, 73728
  s_nop 0
  buffer_load_dwordx4 v2, s[36:39], s93 offen lds
  buffer_load_dwordx4 v3, s[36:39], s93 offen offset:1024 lds
  buffer_load_dwordx4 v2, s[36:39], s93 offen offset:2048 lds
  buffer_load_dwordx4 v3, s[36:39], s93 offen offset:3072 lds
  s_add_u32 m0, s65, 90112
  s_nop 0
  buffer_load_dwordx4 v4, s[40:43], s93 offen lds
  buffer_load_dwordx4 v4, s[44:47], s93 offen offset:1024 lds
  s_waitcnt vmcnt(12)
  s_waitcnt lgkmcnt(0)
  s_barrier
  ds_read_b128 a[16:19], v8 offset:24576
  ds_read_b128 a[20:23], v9 offset:24576
  ds_read_b128 a[24:27], v10 offset:24576
  ds_read_b128 a[28:31], v11 offset:24576
  s_add_u32 m0, s64, 0
  s_nop 0
  buffer_load_dwordx4 v2, s[36:39], s94 offen lds
  buffer_load_dwordx4 v3, s[36:39], s94 offen offset:1024 lds
  buffer_load_dwordx4 v2, s[36:39], s94 offen offset:2048 lds
  buffer_load_dwordx4 v3, s[36:39], s94 offen offset:3072 lds
  s_add_u32 m0, s65, 16384
  s_nop 0
  buffer_load_dwordx4 v4, s[40:43], s94 offen lds
  buffer_load_dwordx4 v4, s[44:47], s94 offen offset:1024 lds
  s_waitcnt vmcnt(12)
  s_waitcnt lgkmcnt(0)
  s_barrier
  ds_read_b128 a[32:35], v8 offset:49152
  ds_read_b128 a[36:39], v9 offset:49152
  ds_read_b128 a[40:43], v10 offset:49152
  ds_read_b128 a[44:47], v11 offset:49152
  s_add_u32 m0, s64, 24576
  s_nop 0
  buffer_load_dwordx4 v2, s[36:39], s95 offen lds
  buffer_load_dwordx4 v3, s[36:39], s95 offen offset:1024 lds
  buffer_load_dwordx4 v2, s[36:39], s95 offen offset:2048 lds
  buffer_load_dwordx4 v3, s[36:39], s95 offen offset:3072 lds
  s_add_u32 m0, s65, 40960
  s_nop 0
  buffer_load_dwordx4 v4, s[40:43], s95 offen lds
  buffer_load_dwordx4 v4, s[44:47], s95 offen offset:1024 lds
  s_waitcnt vmcnt(12)
  s_waitcnt lgkmcnt(0)
  s_barrier
  v_add_u32 v20, 0x10000, v8
  v_add_u32 v21, 0x10000, v9
  v_add_u32 v22, 0x10000, v10
  v_add_u32 v23, 0x10000, v11
  ds_read_b128 a[48:51], v20 offset:8192
  ds_read_b128 a[52:55], v21 offset:8192
  ds_read_b128 a[56:59], v22 offset:8192
  ds_read_b128 a[60:63], v23 offset:8192
  s_add_u32 m0, s64, 49152
  s_nop 0
  buffer_load_dwordx4 v2, s[36:39], s96 offen lds
  buffer_load_dwordx4 v3, s[36:39], s96 offen offset:1024 lds
  buffer_load_dwordx4 v2, s[36:39], s96 offen offset:2048 lds
  buffer_load_dwordx4 v3, s[36:39], s96 offen offset:3072 lds
  s_add_u32 m0, s65, 65536
  s_nop 0
  buffer_load_dwordx4 v4, s[40:43], s96 offen lds
  buffer_load_dwordx4 v4, s[44:47], s96 offen offset:1024 lds
  s_waitcnt vmcnt(12)
  s_waitcnt lgkmcnt(0)
  s_barrier
  ds_read_b128 a[64:67], v8 offset:0
  ds_read_b128 a[68:71], v9 offset:0
  ds_read_b128 a[72:75], v10 offset:0
  ds_read_b128 a[76:79], v11 offset:0
  s_add_u32 m0, s64, 73728
  s_nop 0
  buffer_load_dwordx4 v2, s[36:39], s97 offen lds
  buffer_load_dwordx4 v3, s[36:39], s97 offen offset:1024 lds
  buffer_load_dwordx4 v2, s[36:39], s97 offen offset:2048 lds
  buffer_load_dwordx4 v3, s[36:39], s97 offen offset:3072 lds
  s_add_u32 m0, s65, 90112
  s_nop 0
  buffer_load_dwordx4 v4, s[40:43], s97 offen lds
  buffer_load_dwordx4 v4, s[44:47], s97 offen offset:1024 lds
  s_waitcnt vmcnt(12)
  s_waitcnt lgkmcnt(0)
  s_barrier
  ds_read_b128 a[80:83], v8 offset:24576
  ds_read_b128 a[84:87], v9 offset:24576
  ds_read_b128 a[88:91], v10 offset:24576
  ds_read_b128 a[92:95], v11 offset:24576
  s_add_u32 m0, s65, 98304
  s_nop 0
  buffer_load_dwordx4 v5, s[48:51], s72 offen lds
  buffer_load_dwordx4 v6, s[48:51], s72 offen offset:1024 lds
  s_add_u32 m0, s65, 106496
  s_nop 0
  buffer_load_dwordx4 v5, s[48:51], s73 offen lds
  buffer_load_dwordx4 v6, s[48:51], s73 offen offset:1024 lds
  s_add_u32 m0, s65, 114688
  s_nop 0
  buffer_load_dwordx4 v5, s[48:51], s74 offen lds
  buffer_load_dwordx4 v6, s[48:51], s74 offen offset:1024 lds
  s_waitcnt vmcnt(12)
  s_waitcnt lgkmcnt(0)
  s_barrier
  ds_read_b128 a[96:99], v8 offset:49152
  ds_read_b128 a[100:103], v9 offset:49152
  ds_read_b128 a[104:107], v10 offset:49152
  ds_read_b128 a[108:111], v11 offset:49152
  s_add_u32 m0, s65, 122880
  s_nop 0
  buffer_load_dwordx4 v5, s[48:51], s75 offen lds
  buffer_load_dwordx4 v6, s[48:51], s75 offen offset:1024 lds
  s_add_u32 m0, s65, 131072
  s_nop 0
  buffer_load_dwordx4 v5, s[48:51], s76 offen lds
  buffer_load_dwordx4 v6, s[48:51], s76 offen offset:1024 lds
  s_add_u32 m0, s65, 139264
  s_nop 0
  buffer_load_dwordx4 v5, s[48:51], s77 offen lds
  buffer_load_dwordx4 v6, s[48:51], s77 offen offset:1024 lds
  s_waitcnt vmcnt(12)
  s_waitcnt lgkmcnt(0)
  s_barrier
  v_add_u32 v20, 0x10000, v8
  v_add_u32 v21, 0x10000, v9
  v_add_u32 v22, 0x10000, v10
  v_add_u32 v23, 0x10000, v11
  ds_read_b128 a[112:115], v20 offset:8192
  ds_read_b128 a[116:119], v21 offset:8192
  ds_read_b128 a[120:123], v22 offset:8192
  ds_read_b128 a[124:127], v23 offset:8192
  s_add_u32 m0, s65, 147456
  s_nop 0
  buffer_load_dwordx4 v5, s[48:51], s78 offen lds
  buffer_load_dwordx4 v6, s[48:51], s78 offen offset:1024 lds
  s_add_u32 m0, s65, 155648
  s_nop 0
  buffer_load_dwordx4 v5, s[48:51], s79 offen lds
  buffer_load_dwordx4 v6, s[48:51], s79 offen offset:1024 lds
  s_setprio 3
  s_waitcnt vmcnt(8)
  s_waitcnt lgkmcnt(0)
  s_barrier
  ds_read_b64_tr_b16 v[32:33], v16 offset:32768
  ds_read_b64_tr_b16 v[34:35], v16 offset:33280
  ds_read_b64_tr_b16 v[36:37], v17 offset:32768
  ds_read_b64_tr_b16 v[38:39], v17 offset:33280
  ds_read_b64_tr_b16 v[40:41], v16 offset:34816
  ds_read_b64_tr_b16 v[42:43], v16 offset:35328
  ds_read_b64_tr_b16 v[44:45], v17 offset:34816
  ds_read_b64_tr_b16 v[46:47], v17 offset:35328
  ds_read_b64_tr_b16 v[48:49], v16 offset:36864
  ds_read_b64_tr_b16 v[50:51], v16 offset:37376
  ds_read_b64_tr_b16 v[52:53], v17 offset:36864
  ds_read_b64_tr_b16 v[54:55], v17 offset:37376
  s_waitcnt lgkmcnt(8)
  v_mfma_f32_32x32x16_bf16 v[64:79], v[32:35], a[0:3], 0
  s_add_u32 m0, s65, 0
  s_add_u32 s68, s72, 128
  buffer_load_dwordx4 v5, s[48:51], s68 offen lds
  v_mfma_f32_32x32x16_bf16 v[80:95], v[36:39], a[0:3], 0
  ds_read_b64_tr_b16 v[56:57], v16 offset:38912
  ds_read_b64_tr_b16 v[58:59], v16 offset:39424
  ds_read_b64_tr_b16 v[60:61], v17 offset:38912
  ds_read_b64_tr_b16 v[62:63], v17 offset:39424
  s_waitcnt lgkmcnt(8)
  v_mfma_f32_32x32x16_bf16 v[64:79], v[40:43], a[4:7], v[64:79]
  buffer_load_dwordx4 v6, s[48:51], s68 offen offset:1024 lds
  v_mfma_f32_32x32x16_bf16 v[80:95], v[44:47], a[4:7], v[80:95]
  s_barrier
  ds_read_b64_tr_b16 v[32:33], v16 offset:40960
  ds_read_b64_tr_b16 v[34:35], v16 offset:41472
  ds_read_b64_tr_b16 v[36:37], v17 offset:40960
  ds_read_b64_tr_b16 v[38:39], v17 offset:41472
  s_waitcnt lgkmcnt(8)
  v_mfma_f32_32x32x16_bf16 v[64:79], v[48:51], a[8:11], v[64:79]
  s_add_u32 m0, s65, 8192
  s_add_u32 s68, s73, 128
  buffer_load_dwordx4 v5, s[48:51], s68 offen lds
  v_mfma_f32_32x32x16_bf16 v[80:95], v[52:55], a[8:11], v[80:95]
  ds_read_b64_tr_b16 v[40:41], v16 offset:43008
  ds_read_b64_tr_b16 v[42:43], v16 offset:43520
  ds_read_b64_tr_b16 v[44:45], v17 offset:43008
  ds_read_b64_tr_b16 v[46:47], v17 offset:43520
  s_waitcnt lgkmcnt(8)
  v_mfma_f32_32x32x16_bf16 v[64:79], v[56:59], a[12:15], v[64:79]
  buffer_load_dwordx4 v6, s[48:51], s68 offen offset:1024 lds
  v_mfma_f32_32x32x16_bf16 v[80:95], v[60:63], a[12:15], v[80:95]
  ds_read_b64_tr_b16 v[48:49], v16 offset:45056
  ds_read_b64_tr_b16 v[50:51], v16 offset:45568
  ds_read_b64_tr_b16 v[52:53], v17 offset:45056
  ds_read_b64_tr_b16 v[54:55], v17 offset:45568
  s_waitcnt lgkmcnt(8)
  v_mfma_f32_32x32x16_bf16 v[64:79], v[32:35], a[16:19], v[64:79]
  s_add_u32 m0, s65, 16384
  s_add_u32 s68, s74, 128
  buffer_load_dwordx4 v5, s[48:51], s68 offen lds
  v_mfma_f32_32x32x16_bf16 v[80:95], v[36:39], a[16:19], v[80:95]
  ds_read_b64_tr_b16 v[56:57], v16 offset:47104
  ds_read_b64_tr_b16 v[58:59], v16 offset:47616
  ds_read_b64_tr_b16 v[60:61], v17 offset:47104
  ds_read_b64_tr_b16 v[62:63], v17 offset:47616
  s_waitcnt lgkmcnt(8)
  v_mfma_f32_32x32x16_bf16 v[64:79], v[40:43], a[20:23], v[64:79]
  buffer_load_dwordx4 v6, s[48:51], s68 offen offset:1024 lds
  v_mfma_f32_32x32x16_bf16 v[80:95], v[44:47], a[20:23], v[80:95]
  ds_read_b64_tr_b16 v[32:33], v16 offset:49152
  ds_read_b64_tr_b16 v[34:35], v16 offset:49664
  ds_read_b64_tr_b16 v[36:37], v17 offset:49152
  ds_read_b64_tr_b16 v[38:39], v17 offset:49664
  s_waitcnt lgkmcnt(8)
  v_mfma_f32_32x32x16_bf16 v[64:79], v[48:51], a[24:27], v[64:79]
  s_add_u32 m0, s65, 24576
  s_add_u32 s68, s75, 128
  buffer_load_dwordx4 v5, s[48:51], s68 offen lds
  v_mfma_f32_32x32x16_bf16 v[80:95], v[52:55], a[24:27], v[80:95]
  ds_read_b64_tr_b16 v[40:41], v16 offset:51200
  ds_read_b64_tr_b16 v[42:43], v16 offset:51712
  ds_read_b64_tr_b16 v[44:45], v17 offset:51200
  ds_read_b64_tr_b16 v[46:47], v17 offset:51712
  s_waitcnt lgkmcnt(8)
  v_mfma_f32_32x32x16_bf16 v[64:79], v[56:59], a[28:31], v[64:79]
  buffer_load_dwordx4 v6, s[48:51], s68 offen offset:1024 lds
  v_mfma_f32_32x32x16_bf16 v[80:95], v[60:63], a[28:31], v[80:95]
  ds_read_b64_tr_b16 v[48:49], v16 offset:53248
  ds_read_b64_tr_b16 v[50:51], v16 offset:53760
  ds_read_b64_tr_b16 v[52:53], v17 offset:53248
  ds_read_b64_tr_b16 v[54:55], v17 offset:53760
  s_waitcnt lgkmcnt(8)
  v_mfma_f32_32x32x16_bf16 v[64:79], v[32:35], a[32:35], v[64:79]
  s_add_u32 m0, s65, 32768
  s_add_u32 s68, s76, 128
  buffer_load_dwordx4 v5, s[48:51], s68 offen lds
  v_mfma_f32_32x32x16_bf16 v[80:95], v[36:39], a[32:35], v[80:95]
  ds_read_b64_tr_b16 v[56:57], v16 offset:55296
  ds_read_b64_tr_b16 v[58:59], v16 offset:55808
  ds_read_b64_tr_b16 v[60:61], v17 offset:55296
  ds_read_b64_tr_b16 v[62:63], v17 offset:55808
  s_waitcnt lgkmcnt(8)
  v_mfma_f32_32x32x16_bf16 v[64:79], v[40:43], a[36:39], v[64:79]
  buffer_load_dwordx4 v6, s[48:51], s68 offen offset:1024 lds
  v_mfma_f32_32x32x16_bf16 v[80:95], v[44:47], a[36:39], v[80:95]
  s_waitcnt vmcnt(10)
  s_barrier
  ds_read_b64_tr_b16 v[32:33], v16 offset:57344
  ds_read_b64_tr_b16 v[34:35], v16 offset:57856
  ds_read_b64_tr_b16 v[36:37], v17 offset:57344
  ds_read_b64_tr_b16 v[38:39], v17 offset:57856
  s_waitcnt lgkmcnt(8)
  v_mfma_f32_32x32x16_bf16 v[64:79], v[48:51], a[40:43], v[64:79]
  s_add_u32 m0, s65, 40960
  s_add_u32 s68, s77, 128
  buffer_load_dwordx4 v5, s[48:51], s68 offen lds
  v_mfma_f32_32x32x16_bf16 v[80:95], v[52:55], a[40:43], v[80:95]
  ds_read_b64_tr_b16 v[40:41], v16 offset:59392
  ds_read_b64_tr_b16 v[42:43], v16 offset:59904
  ds_read_b64_tr_b16 v[44:45], v17 offset:59392
  ds_read_b64_tr_b16 v[46:47], v17 offset:59904
  s_waitcnt lgkmcnt(8)
  v_mfma_f32_32x32x16_bf16 v[64:79], v[56:59], a[44:47], v[64:79]
  buffer_load_dwordx4 v6, s[48:51], s68 offen offset:1024 lds
  v_mfma_f32_32x32x16_bf16 v[80:95], v[60:63], a[44:47], v[80:95]
  ds_read_b64_tr_b16 v[48:49], v16 offset:61440
  ds_read_b64_tr_b16 v[50:51], v16 offset:61952
  ds_read_b64_tr_b16 v[52:53], v17 offset:61440
  ds_read_b64_tr_b16 v[54:55], v17 offset:61952
  s_waitcnt lgkmcnt(8)
  v_mfma_f32_32x32x16_bf16 v[64:79], v[32:35], a[48:51], v[64:79]
  s_add_u32 m0, s65, 49152
  s_add_u32 s68, s78, 128
  buffer_load_dwordx4 v5, s[48:51], s68 offen lds
  v_mfma_f32_32x32x16_bf16 v[80:95], v[36:39], a[48:51], v[80:95]
  ds_read_b64_tr_b16 v[56:57], v16 offset:63488
  ds_read_b64_tr_b16 v[58:59], v16 offset:64000
  ds_read_b64_tr_b16 v[60:61], v17 offset:63488
  ds_read_b64_tr_b16 v[62:63], v17 offset:64000
  s_waitcnt lgkmcnt(8)
  v_mfma_f32_32x32x16_bf16 v[64:79], v[40:43], a[52:55], v[64:79]
  buffer_load_dwordx4 v6, s[48:51], s68 offen offset:1024 lds
  v_mfma_f32_32x32x16_bf16 v[80:95], v[44:47], a[52:55], v[80:95]
  ds_read_b64_tr_b16 v[32:33], v18 offset:0
  ds_read_b64_tr_b16 v[34:35], v18 offset:512
  ds_read_b64_tr_b16 v[36:37], v19 offset:0
  ds_read_b64_tr_b16 v[38:39], v19 offset:512
  s_waitcnt lgkmcnt(8)
  v_mfma_f32_32x32x16_bf16 v[64:79], v[48:51], a[56:59], v[64:79]
  s_add_u32 m0, s65, 57344
  s_add_u32 s68, s79, 128
  buffer_load_dwordx4 v5, s[48:51], s68 offen lds
  v_mfma_f32_32x32x16_bf16 v[80:95], v[52:55], a[56:59], v[80:95]
  ds_read_b64_tr_b16 v[40:41], v18 offset:2048
  ds_read_b64_tr_b16 v[42:43], v18 offset:2560
  ds_read_b64_tr_b16 v[44:45], v19 offset:2048
  ds_read_b64_tr_b16 v[46:47], v19 offset:2560
  s_waitcnt lgkmcnt(8)
  v_mfma_f32_32x32x16_bf16 v[64:79], v[56:59], a[60:63], v[64:79]
  buffer_load_dwordx4 v6, s[48:51], s68 offen offset:1024 lds
  v_mfma_f32_32x32x16_bf16 v[80:95], v[60:63], a[60:63], v[80:95]
  ds_read_b64_tr_b16 v[48:49], v18 offset:4096
  ds_read_b64_tr_b16 v[50:51], v18 offset:4608
  ds_read_b64_tr_b16 v[52:53], v19 offset:4096
  ds_read_b64_tr_b16 v[54:55], v19 offset:4608
  s_waitcnt lgkmcnt(8)
  v_mfma_f32_32x32x16_bf16 v[64:79], v[32:35], a[64:67], v[64:79]
  v_mfma_f32_32x32x16_bf16 v[80:95], v[36:39], a[64:67], v[80:95]
  s_barrier
  ds_read_b64_tr_b16 v[56:57], v18 offset:6144
  ds_read_b64_tr_b16 v[58:59], v18 offset:6656
  ds_read_b64_tr_b16 v[60:61], v19 offset:6144
  ds_read_b64_tr_b16 v[62:63], v19 offset:6656
  s_waitcnt lgkmcnt(8)
  v_mfma_f32_32x32x16_bf16 v[64:79], v[40:43], a[68:71], v[64:79]
  v_mfma_f32_32x32x16_bf16 v[80:95], v[44:47], a[68:71], v[80:95]
  ds_read_b64_tr_b16 v[32:33], v18 offset:8192
  ds_read_b64_tr_b16 v[34:35], v18 offset:8704
  ds_read_b64_tr_b16 v[36:37], v19 offset:8192
  ds_read_b64_tr_b16 v[38:39], v19 offset:8704
  s_waitcnt lgkmcnt(8)
  v_mfma_f32_32x32x16_bf16 v[64:79], v[48:51], a[72:75], v[64:79]
  v_mfma_f32_32x32x16_bf16 v[80:95], v[52:55], a[72:75], v[80:95]
  ds_read_b64_tr_b16 v[40:41], v18 offset:10240
  ds_read_b64_tr_b16 v[42:43], v18 offset:10752
  ds_read_b64_tr_b16 v[44:45], v19 offset:10240
  ds_read_b64_tr_b16 v[46:47], v19 offset:10752
  s_waitcnt lgkmcnt(8)
  v_mfma_f32_32x32x16_bf16 v[64:79], v[56:59], a[76:79], v[64:79]
  v_mfma_f32_32x32x16_bf16 v[80:95], v[60:63], a[76:79], v[80:95]
  ds_read_b64_tr_b16 v[48:49], v18 offset:12288
  ds_read_b64_tr_b16 v[50:51], v18 offset:12800
  ds_read_b64_tr_b16 v[52:53], v19 offset:12288
  ds_read_b64_tr_b16 v[54:55], v19 offset:12800
  s_waitcnt lgkmcnt(8)
  v_mfma_f32_32x32x16_bf16 v[64:79], v[32:35], a[80:83], v[64:79]
  v_mfma_f32_32x32x16_bf16 v[80:95], v[36:39], a[80:83], v[80:95]
  ds_read_b64_tr_b16 v[56:57], v18 offset:14336
  ds_read_b64_tr_b16 v[58:59], v18 offset:14848
  ds_read_b64_tr_b16 v[60:61], v19 offset:14336
  ds_read_b64_tr_b16 v[62:63], v19 offset:14848
  s_waitcnt lgkmcnt(8)
  v_mfma_f32_32x32x16_bf16 v[64:79], v[40:43], a[84:87], v[64:79]
  v_mfma_f32_32x32x16_bf16 v[80:95], v[44:47], a[84:87], v[80:95]
  ds_read_b64_tr_b16 v[32:33], v18 offset:16384
  ds_read_b64_tr_b16 v[34:35], v18 offset:16896
  ds_read_b64_tr_b16 v[36:37], v19 offset:16384
  ds_read_b64_tr_b16 v[38:39], v19 offset:16896
  s_waitcnt lgkmcnt(8)
  v_mfma_f32_32x32x16_bf16 v[64:79], v[48:51], a[88:91], v[64:79]
  v_mfma_f32_32x32x16_bf16 v[80:95], v[52:55], a[88:91], v[80:95]
  ds_read_b64_tr_b16 v[40:41], v18 offset:18432
  ds_read_b64_tr_b16 v[42:43], v18 offset:18944
  ds_read_b64_tr_b16 v[44:45], v19 offset:18432
  ds_read_b64_tr_b16 v[46:47], v19 offset:18944
  s_waitcnt lgkmcnt(8)
  v_mfma_f32_32x32x16_bf16 v[64:79], v[56:59], a[92:95], v[64:79]
  v_mfma_f32_32x32x16_bf16 v[80:95], v[60:63], a[92:95], v[80:95]
  ds_read_b64_tr_b16 v[48:49], v18 offset:20480
  ds_read_b64_tr_b16 v[50:51], v18 offset:20992
  ds_read_b64_tr_b16 v[52:53], v19 offset:20480
  ds_read_b64_tr_b16 v[54:55], v19 offset:20992
  s_waitcnt lgkmcnt(8)
  v_mfma_f32_32x32x16_bf16 v[64:79], v[32:35], a[96:99], v[64:79]
  v_mfma_f32_32x32x16_bf16 v[80:95], v[36:39], a[96:99], v[80:95]
  ds_read_b64_tr_b16 v[56:57], v18 offset:22528
  ds_read_b64_tr_b16 v[58:59], v18 offset:23040
  ds_read_b64_tr_b16 v[60:61], v19 offset:22528
  ds_read_b64_tr_b16 v[62:63], v19 offset:23040
  s_waitcnt lgkmcnt(8)
  v_mfma_f32_32x32x16_bf16 v[64:79], v[40:43], a[100:103], v[64:79]
  v_mfma_f32_32x32x16_bf16 v[80:95], v[44:47], a[100:103], v[80:95]
  ds_read_b64_tr_b16 v[32:33], v18 offset:24576
  ds_read_b64_tr_b16 v[34:35], v18 offset:25088
  ds_read_b64_tr_b16 v[36:37], v19 offset:24576
  ds_read_b64_tr_b16 v[38:39], v19 offset:25088
  s_waitcnt lgkmcnt(8)
  v_mfma_f32_32x32x16_bf16 v[64:79], v[48:51], a[104:107], v[64:79]
  v_mfma_f32_32x32x16_bf16 v[80:95], v[52:55], a[104:107], v[80:95]
  ds_read_b64_tr_b16 v[40:41], v18 offset:26624
  ds_read_b64_tr_b16 v[42:43], v18 offset:27136
  ds_read_b64_tr_b16 v[44:45], v19 offset:26624
  ds_read_b64_tr_b16 v[46:47], v19 offset:27136
  s_waitcnt lgkmcnt(8)
  v_mfma_f32_32x32x16_bf16 v[64:79], v[56:59], a[108:111], v[64:79]
  v_mfma_f32_32x32x16_bf16 v[80:95], v[60:63], a[108:111], v[80:95]
  ds_read_b64_tr_b16 v[48:49], v18 offset:28672
  ds_read_b64_tr_b16 v[50:51], v18 offset:29184
  ds_read_b64_tr_b16 v[52:53], v19 offset:28672
  ds_read_b64_tr_b16 v[54:55], v19 offset:29184
  s_waitcnt lgkmcnt(8)
  v_mfma_f32_32x32x16_bf16 v[64:79], v[32:35], a[112:115], v[64:79]
  v_mfma_f32_32x32x16_bf16 v[80:95], v[36:39], a[112:115], v[80:95]
  ds_read_b64_tr_b16 v[56:57], v18 offset:30720
  ds_read_b64_tr_b16 v[58:59], v18 offset:31232
  ds_read_b64_tr_b16 v[60:61], v19 offset:30720
  ds_read_b64_tr_b16 v[62:63], v19 offset:31232
  s_waitcnt lgkmcnt(8)
  v_mfma_f32_32x32x16_bf16 v[64:79], v[40:43], a[116:119], v[64:79]
  v_mfma_f32_32x32x16_bf16 v[80:95], v[44:47], a[116:119], v[80:95]
  s_waitcnt lgkmcnt(4)
  v_mfma_f32_32x32x16_bf16 v[64:79], v[48:51], a[120:123], v[64:79]
  v_mfma_f32_32x32x16_bf16 v[80:95], v[52:55], a[120:123], v[80:95]
  s_waitcnt lgkmcnt(0)
  v_mfma_f32_32x32x16_bf16 v[64:79], v[56:59], a[124:127], v[64:79]
  v_mfma_f32_32x32x16_bf16 v[80:95], v[60:63], a[124:127], v[80:95]
  s_waitcnt vmcnt(0)
  s_barrier
  ds_read_b64_tr_b16 v[32:33], v12 offset:0
  ds_read_b64_tr_b16 v[34:35], v12 offset:512
  ds_read_b64_tr_b16 v[36:37], v13 offset:0
  ds_read_b64_tr_b16 v[38:39], v13 offset:512
  ds_read_b64_tr_b16 v[40:41], v12 offset:2048
  ds_read_b64_tr_b16 v[42:43], v12 offset:2560
  ds_read_b64_tr_b16 v[44:45], v13 offset:2048
  ds_read_b64_tr_b16 v[46:47], v13 offset:2560
  ds_read_b64_tr_b16 v[48:49], v12 offset:4096
  ds_read_b64_tr_b16 v[50:51], v12 offset:4608
  ds_read_b64_tr_b16 v[52:53], v13 offset:4096
  ds_read_b64_tr_b16 v[54:55], v13 offset:4608
  s_waitcnt lgkmcnt(8)
  v_mfma_f32_32x32x16_bf16 v[96:111], v[32:35], a[0:3], 0
  v_mfma_f32_32x32x16_bf16 v[112:127], v[36:39], a[0:3], 0
  v_mul_f32 v20, s66, v64
  v_mul_f32 v21, s66, v65
  v_exp_f32 v20, v20
  v_mul_f32 v22, s66, v66
  ds_read_b64_tr_b16 v[56:57], v12 offset:6144
  ds_read_b64_tr_b16 v[58:59], v12 offset:6656
  ds_read_b64_tr_b16 v[60:61], v13 offset:6144
  ds_read_b64_tr_b16 v[62:63], v13 offset:6656
  s_waitcnt lgkmcnt(8)
  v_mfma_f32_32x32x16_bf16 v[96:111], v[40:43], a[4:7], v[96:111]
  v_exp_f32 v21, v21
  v_add_f32 v20, 1.0, v20
  v_mul_f32 v23, s66, v67
  v_exp_f32 v22, v22
  v_mfma_f32_32x32x16_bf16 v[112:127], v[44:47], a[4:7], v[112:127]
  v_add_f32 v21, 1.0, v21
  v_rcp_f32 v20, v20
  v_mul_f32 v24, s66, v68
  v_exp_f32 v23, v23
  ds_read_b64_tr_b16 v[32:33], v12 offset:8192
  ds_read_b64_tr_b16 v[34:35], v12 offset:8704
  ds_read_b64_tr_b16 v[36:37], v13 offset:8192
  ds_read_b64_tr_b16 v[38:39], v13 offset:8704
  s_waitcnt lgkmcnt(8)
  v_mfma_f32_32x32x16_bf16 v[96:111], v[48:51], a[8:11], v[96:111]
  v_add_f32 v22, 1.0, v22
  v_rcp_f32 v21, v21
  v_mul_f32 v20, v64, v20
  v_mul_f32 v25, s66, v69
  v_mfma_f32_32x32x16_bf16 v[112:127], v[52:55], a[8:11], v[112:127]
  v_exp_f32 v24, v24
  v_add_f32 v23, 1.0, v23
  v_rcp_f32 v22, v22
  v_mul_f32 v21, v65, v21
  ds_read_b64_tr_b16 v[40:41], v12 offset:10240
  ds_read_b64_tr_b16 v[42:43], v12 offset:10752
  ds_read_b64_tr_b16 v[44:45], v13 offset:10240
  ds_read_b64_tr_b16 v[46:47], v13 offset:10752
  s_waitcnt lgkmcnt(8)
  v_mfma_f32_32x32x16_bf16 v[96:111], v[56:59], a[12:15], v[96:111]
  v_mul_f32 v26, s66, v70
  v_exp_f32 v25, v25
  v_add_f32 v24, 1.0, v24
  v_rcp_f32 v23, v23
  v_mfma_f32_32x32x16_bf16 v[112:127], v[60:63], a[12:15], v[112:127]
  v_mul_f32 v22, v66, v22
  v_mul_f32 v27, s66, v71
  v_exp_f32 v26, v26
  v_add_f32 v25, 1.0, v25
  ds_read_b64_tr_b16 v[48:49], v12 offset:12288
  ds_read_b64_tr_b16 v[50:51], v12 offset:12800
  ds_read_b64_tr_b16 v[52:53], v13 offset:12288
  ds_read_b64_tr_b16 v[54:55], v13 offset:12800
  s_waitcnt lgkmcnt(8)
  v_mfma_f32_32x32x16_bf16 v[96:111], v[32:35], a[16:19], v[96:111]
  v_rcp_f32 v24, v24
  v_mul_f32 v23, v67, v23
  v_exp_f32 v27, v27
  v_add_f32 v26, 1.0, v26
  v_mfma_f32_32x32x16_bf16 v[112:127], v[36:39], a[16:19], v[112:127]
  v_rcp_f32 v25, v25
  v_mul_f32 v24, v68, v24
  v_add_f32 v27, 1.0, v27
  v_rcp_f32 v26, v26
  ds_read_b64_tr_b16 v[56:57], v12 offset:14336
  ds_read_b64_tr_b16 v[58:59], v12 offset:14848
  ds_read_b64_tr_b16 v[60:61], v13 offset:14336
  ds_read_b64_tr_b16 v[62:63], v13 offset:14848
  s_waitcnt lgkmcnt(8)
  v_mfma_f32_32x32x16_bf16 v[96:111], v[40:43], a[20:23], v[96:111]
  v_mul_f32 v25, v69, v25
  v_rcp_f32 v27, v27
  v_mul_f32 v26, v70, v26
  v_mul_f32 v27, v71, v27
  v_mfma_f32_32x32x16_bf16 v[112:127], v[44:47], a[20:23], v[112:127]
  v_cvt_pk_bf16_f32 v28, v20, v21
  v_cvt_pk_bf16_f32 v29, v22, v23
  v_cvt_pk_bf16_f32 v30, v24, v25
  v_cvt_pk_bf16_f32 v31, v26, v27
  ds_read_b64_tr_b16 v[32:33], v12 offset:16384
  ds_read_b64_tr_b16 v[34:35], v12 offset:16896
  ds_read_b64_tr_b16 v[36:37], v13 offset:16384
  ds_read_b64_tr_b16 v[38:39], v13 offset:16896
  s_waitcnt lgkmcnt(8)
  v_mfma_f32_32x32x16_bf16 v[96:111], v[48:51], a[24:27], v[96:111]
  s_add_u32 s87, s99, 0
  buffer_store_dwordx4 v[28:31], v7, s[52:55], s87 offen sc0 sc1
  v_mul_f32 v20, s66, v72
  v_mul_f32 v21, s66, v73
  v_mfma_f32_32x32x16_bf16 v[112:127], v[52:55], a[24:27], v[112:127]
  v_exp_f32 v20, v20
  v_mul_f32 v22, s66, v74
  v_exp_f32 v21, v21
  v_add_f32 v20, 1.0, v20
  ds_read_b64_tr_b16 v[40:41], v12 offset:18432
  ds_read_b64_tr_b16 v[42:43], v12 offset:18944
  ds_read_b64_tr_b16 v[44:45], v13 offset:18432
  ds_read_b64_tr_b16 v[46:47], v13 offset:18944
  s_waitcnt lgkmcnt(8)
  v_mfma_f32_32x32x16_bf16 v[96:111], v[56:59], a[28:31], v[96:111]
  v_mul_f32 v23, s66, v75
  v_exp_f32 v22, v22
  v_add_f32 v21, 1.0, v21
  v_rcp_f32 v20, v20
  v_mfma_f32_32x32x16_bf16 v[112:127], v[60:63], a[28:31], v[112:127]
  v_mul_f32 v24, s66, v76
  v_exp_f32 v23, v23
  v_add_f32 v22, 1.0, v22
  v_rcp_f32 v21, v21
  ds_read_b64_tr_b16 v[48:49], v12 offset:20480
  ds_read_b64_tr_b16 v[50:51], v12 offset:20992
  ds_read_b64_tr_b16 v[52:53], v13 offset:20480
  ds_read_b64_tr_b16 v[54:55], v13 offset:20992
  s_waitcnt lgkmcnt(8)
  v_mfma_f32_32x32x16_bf16 v[96:111], v[32:35], a[32:35], v[96:111]
  v_mul_f32 v20, v72, v20
  v_mul_f32 v25, s66, v77
  v_exp_f32 v24, v24
  v_add_f32 v23, 1.0, v23
  v_mfma_f32_32x32x16_bf16 v[112:127], v[36:39], a[32:35], v[112:127]
  v_rcp_f32 v22, v22
  v_mul_f32 v21, v73, v21
  v_mul_f32 v26, s66, v78
  v_exp_f32 v25, v25
  ds_read_b64_tr_b16 v[56:57], v12 offset:22528
  ds_read_b64_tr_b16 v[58:59], v12 offset:23040
  ds_read_b64_tr_b16 v[60:61], v13 offset:22528
  ds_read_b64_tr_b16 v[62:63], v13 offset:23040
  s_waitcnt lgkmcnt(8)
  v_mfma_f32_32x32x16_bf16 v[96:111], v[40:43], a[36:39], v[96:111]
  v_add_f32 v24, 1.0, v24
  v_rcp_f32 v23, v23
  v_mul_f32 v22, v74, v22
  v_mul_f32 v27, s66, v79
  v_mfma_f32_32x32x16_bf16 v[112:127], v[44:47], a[36:39], v[112:127]
  v_exp_f32 v26, v26
  v_add_f32 v25, 1.0, v25
  v_rcp_f32 v24, v24
  v_mul_f32 v23, v75, v23
  ds_read_b64_tr_b16 v[32:33], v12 offset:24576
  ds_read_b64_tr_b16 v[34:35], v12 offset:25088
  ds_read_b64_tr_b16 v[36:37], v13 offset:24576
  ds_read_b64_tr_b16 v[38:39], v13 offset:25088
  s_waitcnt lgkmcnt(8)
  v_mfma_f32_32x32x16_bf16 v[96:111], v[48:51], a[40:43], v[96:111]
  v_exp_f32 v27, v27
  v_add_f32 v26, 1.0, v26
  v_rcp_f32 v25, v25
  v_mul_f32 v24, v76, v24
  v_mfma_f32_32x32x16_bf16 v[112:127], v[52:55], a[40:43], v[112:127]
  v_add_f32 v27, 1.0, v27
  v_rcp_f32 v26, v26
  v_mul_f32 v25, v77, v25
  v_rcp_f32 v27, v27
  ds_read_b64_tr_b16 v[40:41], v12 offset:26624
  ds_read_b64_tr_b16 v[42:43], v12 offset:27136
  ds_read_b64_tr_b16 v[44:45], v13 offset:26624
  ds_read_b64_tr_b16 v[46:47], v13 offset:27136
  s_waitcnt lgkmcnt(8)
  v_mfma_f32_32x32x16_bf16 v[96:111], v[56:59], a[44:47], v[96:111]
  v_mul_f32 v26, v78, v26
  v_mul_f32 v27, v79, v27
  v_cvt_pk_bf16_f32 v28, v20, v21
  v_cvt_pk_bf16_f32 v29, v22, v23
  v_mfma_f32_32x32x16_bf16 v[112:127], v[60:63], a[44:47], v[112:127]
  v_cvt_pk_bf16_f32 v30, v24, v25
  v_cvt_pk_bf16_f32 v31, v26, v27
  s_add_u32 s87, s99, 1024
  buffer_store_dwordx4 v[28:31], v7, s[52:55], s87 offen sc0 sc1
  ds_read_b64_tr_b16 v[48:49], v12 offset:28672
  ds_read_b64_tr_b16 v[50:51], v12 offset:29184
  ds_read_b64_tr_b16 v[52:53], v13 offset:28672
  ds_read_b64_tr_b16 v[54:55], v13 offset:29184
  s_waitcnt lgkmcnt(8)
  v_mfma_f32_32x32x16_bf16 v[96:111], v[32:35], a[48:51], v[96:111]
  v_mul_f32 v20, s66, v80
  v_mul_f32 v21, s66, v81
  v_exp_f32 v20, v20
  v_mul_f32 v22, s66, v82
  v_mfma_f32_32x32x16_bf16 v[112:127], v[36:39], a[48:51], v[112:127]
  v_exp_f32 v21, v21
  v_add_f32 v20, 1.0, v20
  v_mul_f32 v23, s66, v83
  v_exp_f32 v22, v22
  ds_read_b64_tr_b16 v[56:57], v12 offset:30720
  ds_read_b64_tr_b16 v[58:59], v12 offset:31232
  ds_read_b64_tr_b16 v[60:61], v13 offset:30720
  ds_read_b64_tr_b16 v[62:63], v13 offset:31232
  s_waitcnt lgkmcnt(8)
  v_mfma_f32_32x32x16_bf16 v[96:111], v[40:43], a[52:55], v[96:111]
  v_add_f32 v21, 1.0, v21
  v_rcp_f32 v20, v20
  v_mul_f32 v24, s66, v84
  v_exp_f32 v23, v23
  v_mfma_f32_32x32x16_bf16 v[112:127], v[44:47], a[52:55], v[112:127]
  v_add_f32 v22, 1.0, v22
  v_rcp_f32 v21, v21
  v_mul_f32 v20, v80, v20
  v_mul_f32 v25, s66, v85
  ds_read_b64_tr_b16 v[32:33], v12 offset:32768
  ds_read_b64_tr_b16 v[34:35], v12 offset:33280
  ds_read_b64_tr_b16 v[36:37], v13 offset:32768
  ds_read_b64_tr_b16 v[38:39], v13 offset:33280
  s_waitcnt lgkmcnt(8)
  v_mfma_f32_32x32x16_bf16 v[96:111], v[48:51], a[56:59], v[96:111]
  v_exp_f32 v24, v24
  v_add_f32 v23, 1.0, v23
  v_rcp_f32 v22, v22
  v_mul_f32 v21, v81, v21
  v_mfma_f32_32x32x16_bf16 v[112:127], v[52:55], a[56:59], v[112:127]
  v_mul_f32 v26, s66, v86
  v_exp_f32 v25, v25
  v_add_f32 v24, 1.0, v24
  v_rcp_f32 v23, v23
  ds_read_b64_tr_b16 v[40:41], v12 offset:34816
  ds_read_b64_tr_b16 v[42:43], v12 offset:35328
  ds_read_b64_tr_b16 v[44:45], v13 offset:34816
  ds_read_b64_tr_b16 v[46:47], v13 offset:35328
  s_waitcnt lgkmcnt(8)
  v_mfma_f32_32x32x16_bf16 v[96:111], v[56:59], a[60:63], v[96:111]
  v_mul_f32 v22, v82, v22
  v_mul_f32 v27, s66, v87
  v_exp_f32 v26, v26
  v_add_f32 v25, 1.0, v25
  v_mfma_f32_32x32x16_bf16 v[112:127], v[60:63], a[60:63], v[112:127]
  v_rcp_f32 v24, v24
  v_mul_f32 v23, v83, v23
  v_exp_f32 v27, v27
  v_add_f32 v26, 1.0, v26
  ds_read_b64_tr_b16 v[48:49], v12 offset:36864
  ds_read_b64_tr_b16 v[50:51], v12 offset:37376
  ds_read_b64_tr_b16 v[52:53], v13 offset:36864
  ds_read_b64_tr_b16 v[54:55], v13 offset:37376
  s_waitcnt lgkmcnt(8)
  v_mfma_f32_32x32x16_bf16 v[96:111], v[32:35], a[64:67], v[96:111]
  v_rcp_f32 v25, v25
  v_mul_f32 v24, v84, v24
  v_add_f32 v27, 1.0, v27
  v_rcp_f32 v26, v26
  v_mfma_f32_32x32x16_bf16 v[112:127], v[36:39], a[64:67], v[112:127]
  v_mul_f32 v25, v85, v25
  v_rcp_f32 v27, v27
  v_mul_f32 v26, v86, v26
  v_mul_f32 v27, v87, v27
  ds_read_b64_tr_b16 v[56:57], v12 offset:38912
  ds_read_b64_tr_b16 v[58:59], v12 offset:39424
  ds_read_b64_tr_b16 v[60:61], v13 offset:38912
  ds_read_b64_tr_b16 v[62:63], v13 offset:39424
  s_waitcnt lgkmcnt(8)
  v_mfma_f32_32x32x16_bf16 v[96:111], v[40:43], a[68:71], v[96:111]
  v_cvt_pk_bf16_f32 v28, v20, v21
  v_cvt_pk_bf16_f32 v29, v22, v23
  v_cvt_pk_bf16_f32 v30, v24, v25
  v_cvt_pk_bf16_f32 v31, v26, v27
  v_mfma_f32_32x32x16_bf16 v[112:127], v[44:47], a[68:71], v[112:127]
  s_add_u32 s87, s99, 2048
  buffer_store_dwordx4 v[28:31], v7, s[52:55], s87 offen sc0 sc1
  v_mul_f32 v20, s66, v88
  v_mul_f32 v21, s66, v89
  ds_read_b64_tr_b16 v[32:33], v12 offset:40960
  ds_read_b64_tr_b16 v[34:35], v12 offset:41472
  ds_read_b64_tr_b16 v[36:37], v13 offset:40960
  ds_read_b64_tr_b16 v[38:39], v13 offset:41472
  s_waitcnt lgkmcnt(8)
  v_mfma_f32_32x32x16_bf16 v[96:111], v[48:51], a[72:75], v[96:111]
  v_exp_f32 v20, v20
  v_mul_f32 v22, s66, v90
  v_exp_f32 v21, v21
  v_add_f32 v20, 1.0, v20
  v_mfma_f32_32x32x16_bf16 v[112:127], v[52:55], a[72:75], v[112:127]
  v_mul_f32 v23, s66, v91
  v_exp_f32 v22, v22
  v_add_f32 v21, 1.0, v21
  v_rcp_f32 v20, v20
  ds_read_b64_tr_b16 v[40:41], v12 offset:43008
  ds_read_b64_tr_b16 v[42:43], v12 offset:43520
  ds_read_b64_tr_b16 v[44:45], v13 offset:43008
  ds_read_b64_tr_b16 v[46:47], v13 offset:43520
  s_waitcnt lgkmcnt(8)
  v_mfma_f32_32x32x16_bf16 v[96:111], v[56:59], a[76:79], v[96:111]
  v_mul_f32 v24, s66, v92
  v_exp_f32 v23, v23
  v_add_f32 v22, 1.0, v22
  v_rcp_f32 v21, v21
  v_mfma_f32_32x32x16_bf16 v[112:127], v[60:63], a[76:79], v[112:127]
  v_mul_f32 v20, v88, v20
  v_mul_f32 v25, s66, v93
  v_exp_f32 v24, v24
  v_add_f32 v23, 1.0, v23
  ds_read_b64_tr_b16 v[48:49], v12 offset:45056
  ds_read_b64_tr_b16 v[50:51], v12 offset:45568
  ds_read_b64_tr_b16 v[52:53], v13 offset:45056
  ds_read_b64_tr_b16 v[54:55], v13 offset:45568
  s_waitcnt lgkmcnt(8)
  v_mfma_f32_32x32x16_bf16 v[96:111], v[32:35], a[80:83], v[96:111]
  v_rcp_f32 v22, v22
  v_mul_f32 v21, v89, v21
  v_mul_f32 v26, s66, v94
  v_exp_f32 v25, v25
  v_mfma_f32_32x32x16_bf16 v[112:127], v[36:39], a[80:83], v[112:127]
  v_add_f32 v24, 1.0, v24
  v_rcp_f32 v23, v23
  v_mul_f32 v22, v90, v22
  v_mul_f32 v27, s66, v95
  ds_read_b64_tr_b16 v[56:57], v12 offset:47104
  ds_read_b64_tr_b16 v[58:59], v12 offset:47616
  ds_read_b64_tr_b16 v[60:61], v13 offset:47104
  ds_read_b64_tr_b16 v[62:63], v13 offset:47616
  s_waitcnt lgkmcnt(8)
  v_mfma_f32_32x32x16_bf16 v[96:111], v[40:43], a[84:87], v[96:111]
  v_exp_f32 v26, v26
  v_add_f32 v25, 1.0, v25
  v_rcp_f32 v24, v24
  v_mul_f32 v23, v91, v23
  v_mfma_f32_32x32x16_bf16 v[112:127], v[44:47], a[84:87], v[112:127]
  v_exp_f32 v27, v27
  v_add_f32 v26, 1.0, v26
  v_rcp_f32 v25, v25
  v_mul_f32 v24, v92, v24
  ds_read_b64_tr_b16 v[32:33], v12 offset:49152
  ds_read_b64_tr_b16 v[34:35], v12 offset:49664
  ds_read_b64_tr_b16 v[36:37], v13 offset:49152
  ds_read_b64_tr_b16 v[38:39], v13 offset:49664
  s_waitcnt lgkmcnt(8)
  v_mfma_f32_32x32x16_bf16 v[96:111], v[48:51], a[88:91], v[96:111]
  v_add_f32 v27, 1.0, v27
  v_rcp_f32 v26, v26
  v_mul_f32 v25, v93, v25
  v_rcp_f32 v27, v27
  v_mfma_f32_32x32x16_bf16 v[112:127], v[52:55], a[88:91], v[112:127]
  v_mul_f32 v26, v94, v26
  v_mul_f32 v27, v95, v27
  v_cvt_pk_bf16_f32 v28, v20, v21
  v_cvt_pk_bf16_f32 v29, v22, v23
  ds_read_b64_tr_b16 v[40:41], v12 offset:51200
  ds_read_b64_tr_b16 v[42:43], v12 offset:51712
  ds_read_b64_tr_b16 v[44:45], v13 offset:51200
  ds_read_b64_tr_b16 v[46:47], v13 offset:51712
  s_waitcnt lgkmcnt(8)
  v_mfma_f32_32x32x16_bf16 v[96:111], v[56:59], a[92:95], v[96:111]
  v_cvt_pk_bf16_f32 v30, v24, v25
  v_cvt_pk_bf16_f32 v31, v26, v27
  s_add_u32 s87, s99, 3072
  buffer_store_dwordx4 v[28:31], v7, s[52:55], s87 offen sc0 sc1
  v_mfma_f32_32x32x16_bf16 v[112:127], v[60:63], a[92:95], v[112:127]
  ds_read_b64_tr_b16 v[48:49], v12 offset:53248
  ds_read_b64_tr_b16 v[50:51], v12 offset:53760
  ds_read_b64_tr_b16 v[52:53], v13 offset:53248
  ds_read_b64_tr_b16 v[54:55], v13 offset:53760
  s_waitcnt lgkmcnt(8)
  v_mfma_f32_32x32x16_bf16 v[96:111], v[32:35], a[96:99], v[96:111]
  v_mfma_f32_32x32x16_bf16 v[112:127], v[36:39], a[96:99], v[112:127]
  ds_read_b64_tr_b16 v[56:57], v12 offset:55296
  ds_read_b64_tr_b16 v[58:59], v12 offset:55808
  ds_read_b64_tr_b16 v[60:61], v13 offset:55296
  ds_read_b64_tr_b16 v[62:63], v13 offset:55808
  s_waitcnt lgkmcnt(8)
  v_mfma_f32_32x32x16_bf16 v[96:111], v[40:43], a[100:103], v[96:111]
  v_mfma_f32_32x32x16_bf16 v[112:127], v[44:47], a[100:103], v[112:127]
  ds_read_b64_tr_b16 v[32:33], v12 offset:57344
  ds_read_b64_tr_b16 v[34:35], v12 offset:57856
  ds_read_b64_tr_b16 v[36:37], v13 offset:57344
  ds_read_b64_tr_b16 v[38:39], v13 offset:57856
  s_waitcnt lgkmcnt(8)
  v_mfma_f32_32x32x16_bf16 v[96:111], v[48:51], a[104:107], v[96:111]
  v_mfma_f32_32x32x16_bf16 v[112:127], v[52:55], a[104:107], v[112:127]
  ds_read_b64_tr_b16 v[40:41], v12 offset:59392
  ds_read_b64_tr_b16 v[42:43], v12 offset:59904
  ds_read_b64_tr_b16 v[44:45], v13 offset:59392
  ds_read_b64_tr_b16 v[46:47], v13 offset:59904
  s_waitcnt lgkmcnt(8)
  v_mfma_f32_32x32x16_bf16 v[96:111], v[56:59], a[108:111], v[96:111]
  v_mfma_f32_32x32x16_bf16 v[112:127], v[60:63], a[108:111], v[112:127]
  ds_read_b64_tr_b16 v[48:49], v12 offset:61440
  ds_read_b64_tr_b16 v[50:51], v12 offset:61952
  ds_read_b64_tr_b16 v[52:53], v13 offset:61440
  ds_read_b64_tr_b16 v[54:55], v13 offset:61952
  s_waitcnt lgkmcnt(8)
  v_mfma_f32_32x32x16_bf16 v[96:111], v[32:35], a[112:115], v[96:111]
  v_mfma_f32_32x32x16_bf16 v[112:127], v[36:39], a[112:115], v[112:127]
  ds_read_b64_tr_b16 v[56:57], v12 offset:63488
  ds_read_b64_tr_b16 v[58:59], v12 offset:64000
  ds_read_b64_tr_b16 v[60:61], v13 offset:63488
  ds_read_b64_tr_b16 v[62:63], v13 offset:64000
  s_waitcnt lgkmcnt(8)
  v_mfma_f32_32x32x16_bf16 v[96:111], v[40:43], a[116:119], v[96:111]
  v_mfma_f32_32x32x16_bf16 v[112:127], v[44:47], a[116:119], v[112:127]
  s_waitcnt lgkmcnt(4)
  v_mfma_f32_32x32x16_bf16 v[96:111], v[48:51], a[120:123], v[96:111]
  v_mfma_f32_32x32x16_bf16 v[112:127], v[52:55], a[120:123], v[112:127]
  s_waitcnt lgkmcnt(0)
  v_mfma_f32_32x32x16_bf16 v[96:111], v[56:59], a[124:127], v[96:111]
  v_mfma_f32_32x32x16_bf16 v[112:127], v[60:63], a[124:127], v[112:127]
  s_setprio 0
  s_nop 9
  v_pk_mul_f32 v[20:21], v[96:97], s[66:67]
  v_pk_mul_f32 v[22:23], v[98:99], s[66:67]
  v_pk_mul_f32 v[24:25], v[100:101], s[66:67]
  v_pk_mul_f32 v[26:27], v[102:103], s[66:67]
  v_exp_f32 v20, v20
  v_exp_f32 v21, v21
  v_exp_f32 v22, v22
  v_exp_f32 v23, v23
  v_exp_f32 v24, v24
  v_exp_f32 v25, v25
  v_exp_f32 v26, v26
  v_exp_f32 v27, v27
  v_pk_add_f32 v[20:21], v[20:21], 1.0 op_sel_hi:[1,0]
  v_pk_add_f32 v[22:23], v[22:23], 1.0 op_sel_hi:[1,0]
  v_pk_add_f32 v[24:25], v[24:25], 1.0 op_sel_hi:[1,0]
  v_pk_add_f32 v[26:27], v[26:27], 1.0 op_sel_hi:[1,0]
  v_rcp_f32 v20, v20
  v_rcp_f32 v21, v21
  v_rcp_f32 v22, v22
  v_rcp_f32 v23, v23
  v_rcp_f32 v24, v24
  v_rcp_f32 v25, v25
  v_rcp_f32 v26, v26
  v_rcp_f32 v27, v27
  v_pk_mul_f32 v[20:21], v[96:97], v[20:21]
  v_pk_mul_f32 v[22:23], v[98:99], v[22:23]
  v_pk_mul_f32 v[24:25], v[100:101], v[24:25]
  v_pk_mul_f32 v[26:27], v[102:103], v[26:27]
  v_cvt_pk_bf16_f32 v28, v20, v21
  v_cvt_pk_bf16_f32 v29, v22, v23
  v_cvt_pk_bf16_f32 v30, v24, v25
  v_cvt_pk_bf16_f32 v31, v26, v27
  s_add_u32 s87, s99, 4096
  buffer_store_dwordx4 v[28:31], v7, s[52:55], s87 offen sc0 sc1
  v_pk_mul_f32 v[20:21], v[104:105], s[66:67]
  v_pk_mul_f32 v[22:23], v[106:107], s[66:67]
  v_pk_mul_f32 v[24:25], v[108:109], s[66:67]
  v_pk_mul_f32 v[26:27], v[110:111], s[66:67]
  v_exp_f32 v20, v20
  v_exp_f32 v21, v21
  v_exp_f32 v22, v22
  v_exp_f32 v23, v23
  v_exp_f32 v24, v24
  v_exp_f32 v25, v25
  v_exp_f32 v26, v26
  v_exp_f32 v27, v27
  v_pk_add_f32 v[20:21], v[20:21], 1.0 op_sel_hi:[1,0]
  v_pk_add_f32 v[22:23], v[22:23], 1.0 op_sel_hi:[1,0]
  v_pk_add_f32 v[24:25], v[24:25], 1.0 op_sel_hi:[1,0]
  v_pk_add_f32 v[26:27], v[26:27], 1.0 op_sel_hi:[1,0]
  v_rcp_f32 v20, v20
  v_rcp_f32 v21, v21
  v_rcp_f32 v22, v22
  v_rcp_f32 v23, v23
  v_rcp_f32 v24, v24
  v_rcp_f32 v25, v25
  v_rcp_f32 v26, v26
  v_rcp_f32 v27, v27
  v_pk_mul_f32 v[20:21], v[104:105], v[20:21]
  v_pk_mul_f32 v[22:23], v[106:107], v[22:23]
  v_pk_mul_f32 v[24:25], v[108:109], v[24:25]
  v_pk_mul_f32 v[26:27], v[110:111], v[26:27]
  v_cvt_pk_bf16_f32 v28, v20, v21
  v_cvt_pk_bf16_f32 v29, v22, v23
  v_cvt_pk_bf16_f32 v30, v24, v25
  v_cvt_pk_bf16_f32 v31, v26, v27
  s_add_u32 s87, s99, 5120
  buffer_store_dwordx4 v[28:31], v7, s[52:55], s87 offen sc0 sc1
  v_pk_mul_f32 v[20:21], v[112:113], s[66:67]
  v_pk_mul_f32 v[22:23], v[114:115], s[66:67]
  v_pk_mul_f32 v[24:25], v[116:117], s[66:67]
  v_pk_mul_f32 v[26:27], v[118:119], s[66:67]
  v_exp_f32 v20, v20
  v_exp_f32 v21, v21
  v_exp_f32 v22, v22
  v_exp_f32 v23, v23
  v_exp_f32 v24, v24
  v_exp_f32 v25, v25
  v_exp_f32 v26, v26
  v_exp_f32 v27, v27
  v_pk_add_f32 v[20:21], v[20:21], 1.0 op_sel_hi:[1,0]
  v_pk_add_f32 v[22:23], v[22:23], 1.0 op_sel_hi:[1,0]
  v_pk_add_f32 v[24:25], v[24:25], 1.0 op_sel_hi:[1,0]
  v_pk_add_f32 v[26:27], v[26:27], 1.0 op_sel_hi:[1,0]
  v_rcp_f32 v20, v20
  v_rcp_f32 v21, v21
  v_rcp_f32 v22, v22
  v_rcp_f32 v23, v23
  v_rcp_f32 v24, v24
  v_rcp_f32 v25, v25
  v_rcp_f32 v26, v26
  v_rcp_f32 v27, v27
  v_pk_mul_f32 v[20:21], v[112:113], v[20:21]
  v_pk_mul_f32 v[22:23], v[114:115], v[22:23]
  v_pk_mul_f32 v[24:25], v[116:117], v[24:25]
  v_pk_mul_f32 v[26:27], v[118:119], v[26:27]
  v_cvt_pk_bf16_f32 v28, v20, v21
  v_cvt_pk_bf16_f32 v29, v22, v23
  v_cvt_pk_bf16_f32 v30, v24, v25
  v_cvt_pk_bf16_f32 v31, v26, v27
  s_add_u32 s87, s99, 6144
  buffer_store_dwordx4 v[28:31], v7, s[52:55], s87 offen sc0 sc1
  v_pk_mul_f32 v[20:21], v[120:121], s[66:67]
  v_pk_mul_f32 v[22:23], v[122:123], s[66:67]
  v_pk_mul_f32 v[24:25], v[124:125], s[66:67]
  v_pk_mul_f32 v[26:27], v[126:127], s[66:67]
  v_exp_f32 v20, v20
  v_exp_f32 v21, v21
  v_exp_f32 v22, v22
  v_exp_f32 v23, v23
  v_exp_f32 v24, v24
  v_exp_f32 v25, v25
  v_exp_f32 v26, v26
  v_exp_f32 v27, v27
  v_pk_add_f32 v[20:21], v[20:21], 1.0 op_sel_hi:[1,0]
  v_pk_add_f32 v[22:23], v[22:23], 1.0 op_sel_hi:[1,0]
  v_pk_add_f32 v[24:25], v[24:25], 1.0 op_sel_hi:[1,0]
  v_pk_add_f32 v[26:27], v[26:27], 1.0 op_sel_hi:[1,0]
  v_rcp_f32 v20, v20
  v_rcp_f32 v21, v21
  v_rcp_f32 v22, v22
  v_rcp_f32 v23, v23
  v_rcp_f32 v24, v24
  v_rcp_f32 v25, v25
  v_rcp_f32 v26, v26
  v_rcp_f32 v27, v27
  v_pk_mul_f32 v[20:21], v[120:121], v[20:21]
  v_pk_mul_f32 v[22:23], v[122:123], v[22:23]
  v_pk_mul_f32 v[24:25], v[124:125], v[24:25]
  v_pk_mul_f32 v[26:27], v[126:127], v[26:27]
  v_cvt_pk_bf16_f32 v28, v20, v21
  v_cvt_pk_bf16_f32 v29, v22, v23
  v_cvt_pk_bf16_f32 v30, v24, v25
  v_cvt_pk_bf16_f32 v31, v26, v27
  s_add_u32 s87, s99, 7168
  buffer_store_dwordx4 v[28:31], v7, s[52:55], s87 offen sc0 sc1
  s_branch L_p2_F
L_k1_Fn:
  s_add_u32 s90, s56, 0
  s_and_b32 s90, s90, 7
  s_lshl_b32 s90, s90, 7
  s_add_u32 s91, s56, 1
  s_and_b32 s91, s91, 7
  s_lshl_b32 s91, s91, 7
  s_add_u32 s92, s56, 2
  s_and_b32 s92, s92, 7
  s_lshl_b32 s92, s92, 7
  s_add_u32 s93, s56, 3
  s_and_b32 s93, s93, 7
  s_lshl_b32 s93, s93, 7
  s_add_u32 s94, s56, 4
  s_and_b32 s94, s94, 7
  s_lshl_b32 s94, s94, 7
  s_add_u32 s95, s56, 5
  s_and_b32 s95, s95, 7
  s_lshl_b32 s95, s95, 7
  s_add_u32 s96, s56, 6
  s_and_b32 s96, s96, 7
  s_lshl_b32 s96, s96, 7
  s_add_u32 s97, s56, 7
  s_and_b32 s97, s97, 7
  s_lshl_b32 s97, s97, 7
  v_and_b32 v20, 7, v1
  v_lshrrev_b32 v21, 4, v1
  v_xor_b32 v22, v20, v21
  v_lshlrev_b32 v22, 4, v22
  v_lshrrev_b32 v23, 3, v1
  s_lshl_b32 s68, s62, 17
  s_lshl_b32 s69, s61, 15
  s_add_u32 s68, s68, s69
  v_lshlrev_b32 v20, 12, v23
  v_add3_u32 v2, v20, v22, s68
  v_xor_b32 v3, 64, v2
  s_and_b32 s68, s61, 1
  s_lshl_b32 s68, s68, 6
  v_xor_b32 v21, s68, v22
  s_lshl_b32 s68, s61, 13
  s_lshl_b32 s69, s63, 15
  s_add_u32 s68, s68, s69
  v_lshlrev_b32 v20, 10, v23
  v_add3_u32 v4, v20, v21, s68
  s_waitcnt lgkmcnt(0)
  s_mov_b32 s36, s4
  s_mov_b32 s37, s5
  s_mov_b32 s38, 2097152
  s_mov_b32 s39, 0x20000
  s_mov_b32 s40, s10
  s_mov_b32 s41, s11
  s_mov_b32 s42, 524288
  s_mov_b32 s43, 0x20000
  s_sub_u32 s44, s12, 1024
  s_subb_u32 s45, s13, 0
  s_mov_b32 s46, 525312
  s_mov_b32 s47, 0x20000
  s_add_u32 m0, s64, 0
  s_nop 0
  buffer_load_dwordx4 v2, s[36:39], s90 offen lds
  buffer_load_dwordx4 v3, s[36:39], s90 offen offset:1024 lds
  buffer_load_dwordx4 v2, s[36:39], s90 offen offset:2048 lds
  buffer_load_dwordx4 v3, s[36:39], s90 offen offset:3072 lds
  s_add_u32 m0, s65, 16384
  s_nop 0
  buffer_load_dwordx4 v4, s[40:43], s90 offen lds
  buffer_load_dwordx4 v4, s[44:47], s90 offen offset:1024 lds
  s_add_u32 m0, s64, 24576
  s_nop 0
  buffer_load_dwordx4 v2, s[36:39], s91 offen lds
  buffer_load_dwordx4 v3, s[36:39], s91 offen offset:1024 lds
  buffer_load_dwordx4 v2, s[36:39], s91 offen offset:2048 lds
  buffer_load_dwordx4 v3, s[36:39], s91 offen offset:3072 lds
  s_add_u32 m0, s65, 40960
  s_nop 0
  buffer_load_dwordx4 v4, s[40:43], s91 offen lds
  buffer_load_dwordx4 v4, s[44:47], s91 offen offset:1024 lds
  s_add_u32 m0, s64, 49152
  s_nop 0
  buffer_load_dwordx4 v2, s[36:39], s92 offen lds
  buffer_load_dwordx4 v3, s[36:39], s92 offen offset:1024 lds
  buffer_load_dwordx4 v2, s[36:39], s92 offen offset:2048 lds
  buffer_load_dwordx4 v3, s[36:39], s92 offen offset:3072 lds
  s_add_u32 m0, s65, 65536
  s_nop 0
  buffer_load_dwordx4 v4, s[40:43], s92 offen lds
  buffer_load_dwordx4 v4, s[44:47], s92 offen offset:1024 lds
  s_mov_b32 s52, s34
  s_mov_b32 s53, s35
  s_mov_b32 s54, 19022080
  s_mov_b32 s55, 0x20000
  s_waitcnt vmcnt(12)
  s_waitcnt lgkmcnt(0)
  s_barrier
  s_add_u32 m0, s64, 73728
  s_nop 0
  buffer_load_dwordx4 v2, s[36:39], s93 offen lds
  buffer_load_dwordx4 v3, s[36:39], s93 offen offset:1024 lds
  buffer_load_dwordx4 v2, s[36:39], s93 offen offset:2048 lds
  buffer_load_dwordx4 v3, s[36:39], s93 offen offset:3072 lds
  s_add_u32 m0, s65, 90112
  s_nop 0
  buffer_load_dwordx4 v4, s[40:43], s93 offen lds
  buffer_load_dwordx4 v4, s[44:47], s93 offen offset:1024 lds
  s_waitcnt vmcnt(12)
  s_waitcnt lgkmcnt(0)
  s_barrier
  s_add_u32 m0, s64, 0
  s_nop 0
  buffer_load_dwordx4 v2, s[36:39], s94 offen lds
  buffer_load_dwordx4 v3, s[36:39], s94 offen offset:1024 lds
  buffer_load_dwordx4 v2, s[36:39], s94 offen offset:2048 lds
  buffer_load_dwordx4 v3, s[36:39], s94 offen offset:3072 lds
  s_add_u32 m0, s65, 16384
  s_nop 0
  buffer_load_dwordx4 v4, s[40:43], s94 offen lds
  buffer_load_dwordx4 v4, s[44:47], s94 offen offset:1024 lds
  s_waitcnt vmcnt(12)
  s_waitcnt lgkmcnt(0)
  s_barrier
  s_add_u32 m0, s64, 24576
  s_nop 0
  buffer_load_dwordx4 v2, s[36:39], s95 offen lds
  buffer_load_dwordx4 v3, s[36:39], s95 offen offset:1024 lds
  buffer_load_dwordx4 v2, s[36:39], s95 offen offset:2048 lds
  buffer_load_dwordx4 v3, s[36:39], s95 offen offset:3072 lds
  s_add_u32 m0, s65, 40960
  s_nop 0
  buffer_load_dwordx4 v4, s[40:43], s95 offen lds
  buffer_load_dwordx4 v4, s[44:47], s95 offen offset:1024 lds
  s_waitcnt vmcnt(12)
  s_waitcnt lgkmcnt(0)
  s_barrier
  s_add_u32 m0, s64, 49152
  s_nop 0
  buffer_load_dwordx4 v2, s[36:39], s96 offen lds
  buffer_load_dwordx4 v3, s[36:39], s96 offen offset:1024 lds
  buffer_load_dwordx4 v2, s[36:39], s96 offen offset:2048 lds
  buffer_load_dwordx4 v3, s[36:39], s96 offen offset:3072 lds
  s_add_u32 m0, s65, 65536
  s_nop 0
  buffer_load_dwordx4 v4, s[40:43], s96 offen lds
  buffer_load_dwordx4 v4, s[44:47], s96 offen offset:1024 lds
  s_waitcnt vmcnt(12)
  s_waitcnt lgkmcnt(0)
  s_barrier
  s_add_u32 m0, s64, 73728
  s_nop 0
  buffer_load_dwordx4 v2, s[36:39], s97 offen lds
  buffer_load_dwordx4 v3, s[36:39], s97 offen offset:1024 lds
  buffer_load_dwordx4 v2, s[36:39], s97 offen offset:2048 lds
  buffer_load_dwordx4 v3, s[36:39], s97 offen offset:3072 lds
  s_add_u32 m0, s65, 90112
  s_nop 0
  buffer_load_dwordx4 v4, s[40:43], s97 offen lds
  buffer_load_dwordx4 v4, s[44:47], s97 offen offset:1024 lds
  s_waitcnt vmcnt(12)
  s_waitcnt lgkmcnt(0)
  s_barrier
  s_lshl_b32 s68, s62, 1
  s_add_u32 s68, s68, s63
  s_sub_u32 s68, s68, 14
  s_lshl_b32 s68, s68, 2
  s_add_u32 s68, s68, s61
  v_lshlrev_b32 v8, 7, v1
  s_mov_b32 s48, s26
  s_mov_b32 s49, s27
  s_mov_b32 s50, 1835008
  s_mov_b32 s51, 0x20000
  s_mov_b32 s52, s14
  s_mov_b32 s53, s15
  s_mov_b32 s54, 524288
  s_mov_b32 s55, 0x20000
  s_mov_b32 s76, s16
  s_mov_b32 s77, s17
  s_mov_b32 s78, 524288
  s_mov_b32 s79, 0x20000
  s_mul_i32 s69, s68, 14336
  buffer_load_dword v9, v8, s[48:51], s69 offen
  s_add_u32 s69, s69, 8192
  buffer_load_dword v10, v8, s[48:51], s69 offen
  s_lshl_b32 s69, s68, 12
  buffer_load_dword v11, v8, s[52:55], s69 offen
  buffer_load_dword v12, v8, s[76:79], s69 offen
  s_waitcnt vmcnt(10)
  s_waitcnt lgkmcnt(0)
  s_barrier
  s_waitcnt vmcnt(4)
  s_waitcnt lgkmcnt(0)
  s_barrier
  s_lshl_b32 s68, s62, 1
  s_add_u32 s68, s68, s63
  s_sub_u32 s68, s68, 14
  s_lshl_b32 s68, s68, 2
  s_add_u32 s68, s68, s61
  v_and_b32 v120, 31, v1
  v_lshlrev_b32 v120, 4, v120
  global_load_dwordx4 v[112:115], v120, s[28:29]
  global_load_dwordx4 v[116:119], v120, s[28:29] offset:512
  v_lshrrev_b32 v121, 5, v1
  s_lshl_b32 s69, s68, 4
  v_add_u32 v121, s69, v121
  v_lshlrev_b32 v122, 3, v121
  v_add_u32 v122, 14417920, v122
  v_lshlrev_b32 v121, 10, v121
  v_add_u32 v121, v121, v120
  global_load_dwordx4 v[32:35], v121, s[4:5]
  global_load_dwordx4 v[36:39], v121, s[4:5] offset:512
  v_add_u32 v121, 2048, v121
  global_load_dwordx4 v[40:43], v121, s[4:5]
  global_load_dwordx4 v[44:47], v121, s[4:5] offset:512
  v_add_u32 v121, 2048, v121
  global_load_dwordx4 v[48:51], v121, s[4:5]
  global_load_dwordx4 v[52:55], v121, s[4:5] offset:512
  v_add_u32 v121, 2048, v121
  global_load_dwordx4 v[56:59], v121, s[4:5]
  global_load_dwordx4 v[60:63], v121, s[4:5] offset:512
  v_add_u32 v121, 2048, v121
  global_load_dwordx4 v[64:67], v121, s[4:5]
  global_load_dwordx4 v[68:71], v121, s[4:5] offset:512
  v_add_u32 v121, 2048, v121
  global_load_dwordx4 v[72:75], v121, s[4:5]
  global_load_dwordx4 v[76:79], v121, s[4:5] offset:512
  v_add_u32 v121, 2048, v121
  global_load_dwordx4 v[80:83], v121, s[4:5]
  global_load_dwordx4 v[84:87], v121, s[4:5] offset:512
  v_add_u32 v121, 2048, v121
  global_load_dwordx4 v[88:91], v121, s[4:5]
  global_load_dwordx4 v[92:95], v121, s[4:5] offset:512
  s_barrier
  s_barrier
  s_barrier
  s_barrier
  s_barrier
  s_waitcnt vmcnt(17)
  v_lshlrev_b32 v16, 16, v112
  v_and_b32 v17, 0xffff0000, v112
  v_lshlrev_b32 v18, 16, v113
  v_and_b32 v19, 0xffff0000, v113
  v_lshlrev_b32 v20, 16, v114
  v_and_b32 v21, 0xffff0000, v114
  v_lshlrev_b32 v22, 16, v115
  v_and_b32 v23, 0xffff0000, v115
  s_waitcnt vmcnt(16)
  v_lshlrev_b32 v24, 16, v116
  v_and_b32 v25, 0xffff0000, v116
  v_lshlrev_b32 v26, 16, v117
  v_and_b32 v27, 0xffff0000, v117
  v_lshlrev_b32 v28, 16, v118
  v_and_b32 v29, 0xffff0000, v118
  v_lshlrev_b32 v30, 16, v119
  v_and_b32 v31, 0xffff0000, v119
  v_and_b32 v123, 31, v1
  s_waitcnt vmcnt(15)
  v_lshlrev_b32 v98, 16, v32
  v_and_b32 v99, 0xffff0000, v32
  v_pk_mul_f32 v[98:99], v[98:99], v[16:17]
  v_cvt_pk_bf16_f32 v98, v98, v99
  v_and_b32 v99, 0xffff0000, v98
  v_lshlrev_b32 v98, 16, v98
  v_add_f32 v96, v98, v99
  v_lshlrev_b32 v100, 16, v33
  v_and_b32 v101, 0xffff0000, v33
  v_pk_mul_f32 v[100:101], v[100:101], v[18:19]
  v_cvt_pk_bf16_f32 v100, v100, v101
  v_and_b32 v101, 0xffff0000, v100
  v_lshlrev_b32 v100, 16, v100
  v_add_f32 v100, v100, v101
  v_add_f32 v96, v96, v100
  v_lshlrev_b32 v102, 16, v34
  v_and_b32 v103, 0xffff0000, v34
  v_pk_mul_f32 v[102:103], v[102:103], v[20:21]
  v_cvt_pk_bf16_f32 v102, v102, v103
  v_and_b32 v103, 0xffff0000, v102
  v_lshlrev_b32 v102, 16, v102
  v_add_f32 v102, v102, v103
  v_add_f32 v96, v96, v102
  v_lshlrev_b32 v104, 16, v35
  v_and_b32 v105, 0xffff0000, v35
  v_pk_mul_f32 v[104:105], v[104:105], v[22:23]
  v_cvt_pk_bf16_f32 v104, v104, v105
  v_and_b32 v105, 0xffff0000, v104
  v_lshlrev_b32 v104, 16, v104
  v_add_f32 v104, v104, v105
  v_add_f32 v96, v96, v104
  s_waitcnt vmcnt(14)
  v_lshlrev_b32 v98, 16, v36
  v_and_b32 v99, 0xffff0000, v36
  v_pk_mul_f32 v[98:99], v[98:99], v[24:25]
  v_cvt_pk_bf16_f32 v98, v98, v99
  v_and_b32 v99, 0xffff0000, v98
  v_lshlrev_b32 v98, 16, v98
  v_add_f32 v98, v98, v99
  v_add_f32 v96, v96, v98
  v_lshlrev_b32 v100, 16, v37
  v_and_b32 v101, 0xffff0000, v37
  v_pk_mul_f32 v[100:101], v[100:101], v[26:27]
  v_cvt_pk_bf16_f32 v100, v100, v101
  v_and_b32 v101, 0xffff0000, v100
  v_lshlrev_b32 v100, 16, v100
  v_add_f32 v100, v100, v101
  v_add_f32 v96, v96, v100
  v_lshlrev_b32 v102, 16, v38
  v_and_b32 v103, 0xffff0000, v38
  v_pk_mul_f32 v[102:103], v[102:103], v[28:29]
  v_cvt_pk_bf16_f32 v102, v102, v103
  v_and_b32 v103, 0xffff0000, v102
  v_lshlrev_b32 v102, 16, v102
  v_add_f32 v102, v102, v103
  v_add_f32 v96, v96, v102
  v_lshlrev_b32 v104, 16, v39
  v_and_b32 v105, 0xffff0000, v39
  v_pk_mul_f32 v[104:105], v[104:105], v[30:31]
  v_cvt_pk_bf16_f32 v104, v104, v105
  v_and_b32 v105, 0xffff0000, v104
  v_lshlrev_b32 v104, 16, v104
  v_add_f32 v104, v104, v105
  v_add_f32 v96, v96, v104
  s_nop 1
  v_add_f32_dpp v96, v96, v96 row_ror:8 row_mask:0xf bank_mask:0xf
  s_nop 1
  v_add_f32_dpp v96, v96, v96 row_ror:4 row_mask:0xf bank_mask:0xf
  s_nop 1
  v_add_f32_dpp v96, v96, v96 row_ror:2 row_mask:0xf bank_mask:0xf
  s_nop 1
  v_add_f32_dpp v96, v96, v96 row_ror:1 row_mask:0xf bank_mask:0xf
  v_mov_b32 v97, v96
  s_nop 1
  v_permlane16_swap_b32 v96, v97
  v_add_f32 v96, v96, v97
  v_cvt_pk_bf16_f32 v96, v96, v96
  v_lshlrev_b32 v96, 16, v96
  v_mul_f32 v96, 0xbfb8aa3b, v96
  v_exp_f32 v96, v96
  s_nop 0
  v_add_f32 v96, 1.0, v96
  v_rcp_f32 v96, v96
  s_nop 0
  v_cvt_pk_bf16_f32 v96, v96, v96
  v_lshlrev_b32 v32, 16, v96
  v_sub_f32 v33, 1.0, v32
  v_cvt_pk_bf16_f32 v33, v33, v33
  v_lshlrev_b32 v33, 16, v33
  s_waitcnt vmcnt(13)
  v_lshlrev_b32 v98, 16, v40
  v_and_b32 v99, 0xffff0000, v40
  v_pk_mul_f32 v[98:99], v[98:99], v[16:17]
  v_cvt_pk_bf16_f32 v98, v98, v99
  v_and_b32 v99, 0xffff0000, v98
  v_lshlrev_b32 v98, 16, v98
  v_add_f32 v96, v98, v99
  v_lshlrev_b32 v100, 16, v41
  v_and_b32 v101, 0xffff0000, v41
  v_pk_mul_f32 v[100:101], v[100:101], v[18:19]
  v_cvt_pk_bf16_f32 v100, v100, v101
  v_and_b32 v101, 0xffff0000, v100
  v_lshlrev_b32 v100, 16, v100
  v_add_f32 v100, v100, v101
  v_add_f32 v96, v96, v100
  v_lshlrev_b32 v102, 16, v42
  v_and_b32 v103, 0xffff0000, v42
  v_pk_mul_f32 v[102:103], v[102:103], v[20:21]
  v_cvt_pk_bf16_f32 v102, v102, v103
  v_and_b32 v103, 0xffff0000, v102
  v_lshlrev_b32 v102, 16, v102
  v_add_f32 v102, v102, v103
  v_add_f32 v96, v96, v102
  v_lshlrev_b32 v104, 16, v43
  v_and_b32 v105, 0xffff0000, v43
  v_pk_mul_f32 v[104:105], v[104:105], v[22:23]
  v_cvt_pk_bf16_f32 v104, v104, v105
  v_and_b32 v105, 0xffff0000, v104
  v_lshlrev_b32 v104, 16, v104
  v_add_f32 v104, v104, v105
  v_add_f32 v96, v96, v104
  s_waitcnt vmcnt(12)
  v_lshlrev_b32 v98, 16, v44
  v_and_b32 v99, 0xffff0000, v44
  v_pk_mul_f32 v[98:99], v[98:99], v[24:25]
  v_cvt_pk_bf16_f32 v98, v98, v99
  v_and_b32 v99, 0xffff0000, v98
  v_lshlrev_b32 v98, 16, v98
  v_add_f32 v98, v98, v99
  v_add_f32 v96, v96, v98
  v_lshlrev_b32 v100, 16, v45
  v_and_b32 v101, 0xffff0000, v45
  v_pk_mul_f32 v[100:101], v[100:101], v[26:27]
  v_cvt_pk_bf16_f32 v100, v100, v101
  v_and_b32 v101, 0xffff0000, v100
  v_lshlrev_b32 v100, 16, v100
  v_add_f32 v100, v100, v101
  v_add_f32 v96, v96, v100
  v_lshlrev_b32 v102, 16, v46
  v_and_b32 v103, 0xffff0000, v46
  v_pk_mul_f32 v[102:103], v[102:103], v[28:29]
  v_cvt_pk_bf16_f32 v102, v102, v103
  v_and_b32 v103, 0xffff0000, v102
  v_lshlrev_b32 v102, 16, v102
  v_add_f32 v102, v102, v103
  v_add_f32 v96, v96, v102
  v_lshlrev_b32 v104, 16, v47
  v_and_b32 v105, 0xffff0000, v47
  v_pk_mul_f32 v[104:105], v[104:105], v[30:31]
  v_cvt_pk_bf16_f32 v104, v104, v105
  v_and_b32 v105, 0xffff0000, v104
  v_lshlrev_b32 v104, 16, v104
  v_add_f32 v104, v104, v105
  v_add_f32 v96, v96, v104
  s_nop 1
  v_add_f32_dpp v96, v96, v96 row_ror:8 row_mask:0xf bank_mask:0xf
  s_nop 1
  v_add_f32_dpp v96, v96, v96 row_ror:4 row_mask:0xf bank_mask:0xf
  s_nop 1
  v_add_f32_dpp v96, v96, v96 row_ror:2 row_mask:0xf bank_mask:0xf
  s_nop 1
  v_add_f32_dpp v96, v96, v96 row_ror:1 row_mask:0xf bank_mask:0xf
  v_mov_b32 v97, v96
  s_nop 1
  v_permlane16_swap_b32 v96, v97
  v_add_f32 v96, v96, v97
  v_cvt_pk_bf16_f32 v96, v96, v96
  v_lshlrev_b32 v96, 16, v96
  v_mul_f32 v96, 0xbfb8aa3b, v96
  v_exp_f32 v96, v96
  s_nop 0
  v_add_f32 v96, 1.0, v96
  v_rcp_f32 v96, v96
  s_nop 0
  v_cvt_pk_bf16_f32 v96, v96, v96
  v_lshlrev_b32 v40, 16, v96
  v_sub_f32 v41, 1.0, v40
  v_cvt_pk_bf16_f32 v41, v41, v41
  v_lshlrev_b32 v41, 16, v41
  s_waitcnt vmcnt(11)
  v_lshlrev_b32 v98, 16, v48
  v_and_b32 v99, 0xffff0000, v48
  v_pk_mul_f32 v[98:99], v[98:99], v[16:17]
  v_cvt_pk_bf16_f32 v98, v98, v99
  v_and_b32 v99, 0xffff0000, v98
  v_lshlrev_b32 v98, 16, v98
  v_add_f32 v96, v98, v99
  v_lshlrev_b32 v100, 16, v49
  v_and_b32 v101, 0xffff0000, v49
  v_pk_mul_f32 v[100:101], v[100:101], v[18:19]
  v_cvt_pk_bf16_f32 v100, v100, v101
  v_and_b32 v101, 0xffff0000, v100
  v_lshlrev_b32 v100, 16, v100
  v_add_f32 v100, v100, v101
  v_add_f32 v96, v96, v100
  v_lshlrev_b32 v102, 16, v50
  v_and_b32 v103, 0xffff0000, v50
  v_pk_mul_f32 v[102:103], v[102:103], v[20:21]
  v_cvt_pk_bf16_f32 v102, v102, v103
  v_and_b32 v103, 0xffff0000, v102
  v_lshlrev_b32 v102, 16, v102
  v_add_f32 v102, v102, v103
  v_add_f32 v96, v96, v102
  v_lshlrev_b32 v104, 16, v51
  v_and_b32 v105, 0xffff0000, v51
  v_pk_mul_f32 v[104:105], v[104:105], v[22:23]
  v_cvt_pk_bf16_f32 v104, v104, v105
  v_and_b32 v105, 0xffff0000, v104
  v_lshlrev_b32 v104, 16, v104
  v_add_f32 v104, v104, v105
  v_add_f32 v96, v96, v104
  s_waitcnt vmcnt(10)
  v_lshlrev_b32 v98, 16, v52
  v_and_b32 v99, 0xffff0000, v52
  v_pk_mul_f32 v[98:99], v[98:99], v[24:25]
  v_cvt_pk_bf16_f32 v98, v98, v99
  v_and_b32 v99, 0xffff0000, v98
  v_lshlrev_b32 v98, 16, v98
  v_add_f32 v98, v98, v99
  v_add_f32 v96, v96, v98
  v_lshlrev_b32 v100, 16, v53
  v_and_b32 v101, 0xffff0000, v53
  v_pk_mul_f32 v[100:101], v[100:101], v[26:27]
  v_cvt_pk_bf16_f32 v100, v100, v101
  v_and_b32 v101, 0xffff0000, v100
  v_lshlrev_b32 v100, 16, v100
  v_add_f32 v100, v100, v101
  v_add_f32 v96, v96, v100
  v_lshlrev_b32 v102, 16, v54
  v_and_b32 v103, 0xffff0000, v54
  v_pk_mul_f32 v[102:103], v[102:103], v[28:29]
  v_cvt_pk_bf16_f32 v102, v102, v103
  v_and_b32 v103, 0xffff0000, v102
  v_lshlrev_b32 v102, 16, v102
  v_add_f32 v102, v102, v103
  v_add_f32 v96, v96, v102
  v_lshlrev_b32 v104, 16, v55
  v_and_b32 v105, 0xffff0000, v55
  v_pk_mul_f32 v[104:105], v[104:105], v[30:31]
  v_cvt_pk_bf16_f32 v104, v104, v105
  v_and_b32 v105, 0xffff0000, v104
  v_lshlrev_b32 v104, 16, v104
  v_add_f32 v104, v104, v105
  v_add_f32 v96, v96, v104
  s_nop 1
  v_add_f32_dpp v96, v96, v96 row_ror:8 row_mask:0xf bank_mask:0xf
  s_nop 1
  v_add_f32_dpp v96, v96, v96 row_ror:4 row_mask:0xf bank_mask:0xf
  s_nop 1
  v_add_f32_dpp v96, v96, v96 row_ror:2 row_mask:0xf bank_mask:0xf
  s_nop 1
  v_add_f32_dpp v96, v96, v96 row_ror:1 row_mask:0xf bank_mask:0xf
  v_mov_b32 v97, v96
  s_nop 1
  v_permlane16_swap_b32 v96, v97
  v_add_f32 v96, v96, v97
  v_cvt_pk_bf16_f32 v96, v96, v96
  v_lshlrev_b32 v96, 16, v96
  v_mul_f32 v96, 0xbfb8aa3b, v96
  v_exp_f32 v96, v96
  s_nop 0
  v_add_f32 v96, 1.0, v96
  v_rcp_f32 v96, v96
  s_nop 0
  v_cvt_pk_bf16_f32 v96, v96, v96
  v_lshlrev_b32 v48, 16, v96
  v_sub_f32 v49, 1.0, v48
  v_cvt_pk_bf16_f32 v49, v49, v49
  v_lshlrev_b32 v49, 16, v49
  s_waitcnt vmcnt(9)
  v_lshlrev_b32 v98, 16, v56
  v_and_b32 v99, 0xffff0000, v56
  v_pk_mul_f32 v[98:99], v[98:99], v[16:17]
  v_cvt_pk_bf16_f32 v98, v98, v99
  v_and_b32 v99, 0xffff0000, v98
  v_lshlrev_b32 v98, 16, v98
  v_add_f32 v96, v98, v99
  v_lshlrev_b32 v100, 16, v57
  v_and_b32 v101, 0xffff0000, v57
  v_pk_mul_f32 v[100:101], v[100:101], v[18:19]
  v_cvt_pk_bf16_f32 v100, v100, v101
  v_and_b32 v101, 0xffff0000, v100
  v_lshlrev_b32 v100, 16, v100
  v_add_f32 v100, v100, v101
  v_add_f32 v96, v96, v100
  v_lshlrev_b32 v102, 16, v58
  v_and_b32 v103, 0xffff0000, v58
  v_pk_mul_f32 v[102:103], v[102:103], v[20:21]
  v_cvt_pk_bf16_f32 v102, v102, v103
  v_and_b32 v103, 0xffff0000, v102
  v_lshlrev_b32 v102, 16, v102
  v_add_f32 v102, v102, v103
  v_add_f32 v96, v96, v102
  v_lshlrev_b32 v104, 16, v59
  v_and_b32 v105, 0xffff0000, v59
  v_pk_mul_f32 v[104:105], v[104:105], v[22:23]
  v_cvt_pk_bf16_f32 v104, v104, v105
  v_and_b32 v105, 0xffff0000, v104
  v_lshlrev_b32 v104, 16, v104
  v_add_f32 v104, v104, v105
  v_add_f32 v96, v96, v104
  s_waitcnt vmcnt(8)
  v_lshlrev_b32 v98, 16, v60
  v_and_b32 v99, 0xffff0000, v60
  v_pk_mul_f32 v[98:99], v[98:99], v[24:25]
  v_cvt_pk_bf16_f32 v98, v98, v99
  v_and_b32 v99, 0xffff0000, v98
  v_lshlrev_b32 v98, 16, v98
  v_add_f32 v98, v98, v99
  v_add_f32 v96, v96, v98
  v_lshlrev_b32 v100, 16, v61
  v_and_b32 v101, 0xffff0000, v61
  v_pk_mul_f32 v[100:101], v[100:101], v[26:27]
  v_cvt_pk_bf16_f32 v100, v100, v101
  v_and_b32 v101, 0xffff0000, v100
  v_lshlrev_b32 v100, 16, v100
  v_add_f32 v100, v100, v101
  v_add_f32 v96, v96, v100
  v_lshlrev_b32 v102, 16, v62
  v_and_b32 v103, 0xffff0000, v62
  v_pk_mul_f32 v[102:103], v[102:103], v[28:29]
  v_cvt_pk_bf16_f32 v102, v102, v103
  v_and_b32 v103, 0xffff0000, v102
  v_lshlrev_b32 v102, 16, v102
  v_add_f32 v102, v102, v103
  v_add_f32 v96, v96, v102
  v_lshlrev_b32 v104, 16, v63
  v_and_b32 v105, 0xffff0000, v63
  v_pk_mul_f32 v[104:105], v[104:105], v[30:31]
  v_cvt_pk_bf16_f32 v104, v104, v105
  v_and_b32 v105, 0xffff0000, v104
  v_lshlrev_b32 v104, 16, v104
  v_add_f32 v104, v104, v105
  v_add_f32 v96, v96, v104
  s_nop 1
  v_add_f32_dpp v96, v96, v96 row_ror:8 row_mask:0xf bank_mask:0xf
  s_nop 1
  v_add_f32_dpp v96, v96, v96 row_ror:4 row_mask:0xf bank_mask:0xf
  s_nop 1
  v_add_f32_dpp v96, v96, v96 row_ror:2 row_mask:0xf bank_mask:0xf
  s_nop 1
  v_add_f32_dpp v96, v96, v96 row_ror:1 row_mask:0xf bank_mask:0xf
  v_mov_b32 v97, v96
  s_nop 1
  v_permlane16_swap_b32 v96, v97
  v_add_f32 v96, v96, v97
  v_cvt_pk_bf16_f32 v96, v96, v96
  v_lshlrev_b32 v96, 16, v96
  v_mul_f32 v96, 0xbfb8aa3b, v96
  v_exp_f32 v96, v96
  s_nop 0
  v_add_f32 v96, 1.0, v96
  v_rcp_f32 v96, v96
  s_nop 0
  v_cvt_pk_bf16_f32 v96, v96, v96
  v_lshlrev_b32 v56, 16, v96
  v_sub_f32 v57, 1.0, v56
  v_cvt_pk_bf16_f32 v57, v57, v57
  v_lshlrev_b32 v57, 16, v57
  s_waitcnt vmcnt(7)
  v_lshlrev_b32 v98, 16, v64
  v_and_b32 v99, 0xffff0000, v64
  v_pk_mul_f32 v[98:99], v[98:99], v[16:17]
  v_cvt_pk_bf16_f32 v98, v98, v99
  v_and_b32 v99, 0xffff0000, v98
  v_lshlrev_b32 v98, 16, v98
  v_add_f32 v96, v98, v99
  v_lshlrev_b32 v100, 16, v65
  v_and_b32 v101, 0xffff0000, v65
  v_pk_mul_f32 v[100:101], v[100:101], v[18:19]
  v_cvt_pk_bf16_f32 v100, v100, v101
  v_and_b32 v101, 0xffff0000, v100
  v_lshlrev_b32 v100, 16, v100
  v_add_f32 v100, v100, v101
  v_add_f32 v96, v96, v100
  v_lshlrev_b32 v102, 16, v66
  v_and_b32 v103, 0xffff0000, v66
  v_pk_mul_f32 v[102:103], v[102:103], v[20:21]
  v_cvt_pk_bf16_f32 v102, v102, v103
  v_and_b32 v103, 0xffff0000, v102
  v_lshlrev_b32 v102, 16, v102
  v_add_f32 v102, v102, v103
  v_add_f32 v96, v96, v102
  v_lshlrev_b32 v104, 16, v67
  v_and_b32 v105, 0xffff0000, v67
  v_pk_mul_f32 v[104:105], v[104:105], v[22:23]
  v_cvt_pk_bf16_f32 v104, v104, v105
  v_and_b32 v105, 0xffff0000, v104
  v_lshlrev_b32 v104, 16, v104
  v_add_f32 v104, v104, v105
  v_add_f32 v96, v96, v104
  s_waitcnt vmcnt(6)
  v_lshlrev_b32 v98, 16, v68
  v_and_b32 v99, 0xffff0000, v68
  v_pk_mul_f32 v[98:99], v[98:99], v[24:25]
  v_cvt_pk_bf16_f32 v98, v98, v99
  v_and_b32 v99, 0xffff0000, v98
  v_lshlrev_b32 v98, 16, v98
  v_add_f32 v98, v98, v99
  v_add_f32 v96, v96, v98
  v_lshlrev_b32 v100, 16, v69
  v_and_b32 v101, 0xffff0000, v69
  v_pk_mul_f32 v[100:101], v[100:101], v[26:27]
  v_cvt_pk_bf16_f32 v100, v100, v101
  v_and_b32 v101, 0xffff0000, v100
  v_lshlrev_b32 v100, 16, v100
  v_add_f32 v100, v100, v101
  v_add_f32 v96, v96, v100
  v_lshlrev_b32 v102, 16, v70
  v_and_b32 v103, 0xffff0000, v70
  v_pk_mul_f32 v[102:103], v[102:103], v[28:29]
  v_cvt_pk_bf16_f32 v102, v102, v103
  v_and_b32 v103, 0xffff0000, v102
  v_lshlrev_b32 v102, 16, v102
  v_add_f32 v102, v102, v103
  v_add_f32 v96, v96, v102
  v_lshlrev_b32 v104, 16, v71
  v_and_b32 v105, 0xffff0000, v71
  v_pk_mul_f32 v[104:105], v[104:105], v[30:31]
  v_cvt_pk_bf16_f32 v104, v104, v105
  v_and_b32 v105, 0xffff0000, v104
  v_lshlrev_b32 v104, 16, v104
  v_add_f32 v104, v104, v105
  v_add_f32 v96, v96, v104
  s_nop 1
  v_add_f32_dpp v96, v96, v96 row_ror:8 row_mask:0xf bank_mask:0xf
  s_nop 1
  v_add_f32_dpp v96, v96, v96 row_ror:4 row_mask:0xf bank_mask:0xf
  s_nop 1
  v_add_f32_dpp v96, v96, v96 row_ror:2 row_mask:0xf bank_mask:0xf
  s_nop 1
  v_add_f32_dpp v96, v96, v96 row_ror:1 row_mask:0xf bank_mask:0xf
  v_mov_b32 v97, v96
  s_nop 1
  v_permlane16_swap_b32 v96, v97
  v_add_f32 v96, v96, v97
  v_cvt_pk_bf16_f32 v96, v96, v96
  v_lshlrev_b32 v96, 16, v96
  v_mul_f32 v96, 0xbfb8aa3b, v96
  v_exp_f32 v96, v96
  s_nop 0
  v_add_f32 v96, 1.0, v96
  v_rcp_f32 v96, v96
  s_nop 0
  v_cvt_pk_bf16_f32 v96, v96, v96
  v_lshlrev_b32 v64, 16, v96
  v_sub_f32 v65, 1.0, v64
  v_cvt_pk_bf16_f32 v65, v65, v65
  v_lshlrev_b32 v65, 16, v65
  s_waitcnt vmcnt(5)
  v_lshlrev_b32 v98, 16, v72
  v_and_b32 v99, 0xffff0000, v72
  v_pk_mul_f32 v[98:99], v[98:99], v[16:17]
  v_cvt_pk_bf16_f32 v98, v98, v99
  v_and_b32 v99, 0xffff0000, v98
  v_lshlrev_b32 v98, 16, v98
  v_add_f32 v96, v98, v99
  v_lshlrev_b32 v100, 16, v73
  v_and_b32 v101, 0xffff0000, v73
  v_pk_mul_f32 v[100:101], v[100:101], v[18:19]
  v_cvt_pk_bf16_f32 v100, v100, v101
  v_and_b32 v101, 0xffff0000, v100
  v_lshlrev_b32 v100, 16, v100
  v_add_f32 v100, v100, v101
  v_add_f32 v96, v96, v100
  v_lshlrev_b32 v102, 16, v74
  v_and_b32 v103, 0xffff0000, v74
  v_pk_mul_f32 v[102:103], v[102:103], v[20:21]
  v_cvt_pk_bf16_f32 v102, v102, v103
  v_and_b32 v103, 0xffff0000, v102
  v_lshlrev_b32 v102, 16, v102
  v_add_f32 v102, v102, v103
  v_add_f32 v96, v96, v102
  v_lshlrev_b32 v104, 16, v75
  v_and_b32 v105, 0xffff0000, v75
  v_pk_mul_f32 v[104:105], v[104:105], v[22:23]
  v_cvt_pk_bf16_f32 v104, v104, v105
  v_and_b32 v105, 0xffff0000, v104
  v_lshlrev_b32 v104, 16, v104
  v_add_f32 v104, v104, v105
  v_add_f32 v96, v96, v104
  s_waitcnt vmcnt(4)
  v_lshlrev_b32 v98, 16, v76
  v_and_b32 v99, 0xffff0000, v76
  v_pk_mul_f32 v[98:99], v[98:99], v[24:25]
  v_cvt_pk_bf16_f32 v98, v98, v99
  v_and_b32 v99, 0xffff0000, v98
  v_lshlrev_b32 v98, 16, v98
  v_add_f32 v98, v98, v99
  v_add_f32 v96, v96, v98
  v_lshlrev_b32 v100, 16, v77
  v_and_b32 v101, 0xffff0000, v77
  v_pk_mul_f32 v[100:101], v[100:101], v[26:27]
  v_cvt_pk_bf16_f32 v100, v100, v101
  v_and_b32 v101, 0xffff0000, v100
  v_lshlrev_b32 v100, 16, v100
  v_add_f32 v100, v100, v101
  v_add_f32 v96, v96, v100
  v_lshlrev_b32 v102, 16, v78
  v_and_b32 v103, 0xffff0000, v78
  v_pk_mul_f32 v[102:103], v[102:103], v[28:29]
  v_cvt_pk_bf16_f32 v102, v102, v103
  v_and_b32 v103, 0xffff0000, v102
  v_lshlrev_b32 v102, 16, v102
  v_add_f32 v102, v102, v103
  v_add_f32 v96, v96, v102
  v_lshlrev_b32 v104, 16, v79
  v_and_b32 v105, 0xffff0000, v79
  v_pk_mul_f32 v[104:105], v[104:105], v[30:31]
  v_cvt_pk_bf16_f32 v104, v104, v105
  v_and_b32 v105, 0xffff0000, v104
  v_lshlrev_b32 v104, 16, v104
  v_add_f32 v104, v104, v105
  v_add_f32 v96, v96, v104
  s_nop 1
  v_add_f32_dpp v96, v96, v96 row_ror:8 row_mask:0xf bank_mask:0xf
  s_nop 1
  v_add_f32_dpp v96, v96, v96 row_ror:4 row_mask:0xf bank_mask:0xf
  s_nop 1
  v_add_f32_dpp v96, v96, v96 row_ror:2 row_mask:0xf bank_mask:0xf
  s_nop 1
  v_add_f32_dpp v96, v96, v96 row_ror:1 row_mask:0xf bank_mask:0xf
  v_mov_b32 v97, v96
  s_nop 1
  v_permlane16_swap_b32 v96, v97
  v_add_f32 v96, v96, v97
  v_cvt_pk_bf16_f32 v96, v96, v96
  v_lshlrev_b32 v96, 16, v96
  v_mul_f32 v96, 0xbfb8aa3b, v96
  v_exp_f32 v96, v96
  s_nop 0
  v_add_f32 v96, 1.0, v96
  v_rcp_f32 v96, v96
  s_nop 0
  v_cvt_pk_bf16_f32 v96, v96, v96
  v_lshlrev_b32 v72, 16, v96
  v_sub_f32 v73, 1.0, v72
  v_cvt_pk_bf16_f32 v73, v73, v73
  v_lshlrev_b32 v73, 16, v73
  s_waitcnt vmcnt(3)
  v_lshlrev_b32 v98, 16, v80
  v_and_b32 v99, 0xffff0000, v80
  v_pk_mul_f32 v[98:99], v[98:99], v[16:17]
  v_cvt_pk_bf16_f32 v98, v98, v99
  v_and_b32 v99, 0xffff0000, v98
  v_lshlrev_b32 v98, 16, v98
  v_add_f32 v96, v98, v99
  v_lshlrev_b32 v100, 16, v81
  v_and_b32 v101, 0xffff0000, v81
  v_pk_mul_f32 v[100:101], v[100:101], v[18:19]
  v_cvt_pk_bf16_f32 v100, v100, v101
  v_and_b32 v101, 0xffff0000, v100
  v_lshlrev_b32 v100, 16, v100
  v_add_f32 v100, v100, v101
  v_add_f32 v96, v96, v100
  v_lshlrev_b32 v102, 16, v82
  v_and_b32 v103, 0xffff0000, v82
  v_pk_mul_f32 v[102:103], v[102:103], v[20:21]
  v_cvt_pk_bf16_f32 v102, v102, v103
  v_and_b32 v103, 0xffff0000, v102
  v_lshlrev_b32 v102, 16, v102
  v_add_f32 v102, v102, v103
  v_add_f32 v96, v96, v102
  v_lshlrev_b32 v104, 16, v83
  v_and_b32 v105, 0xffff0000, v83
  v_pk_mul_f32 v[104:105], v[104:105], v[22:23]
  v_cvt_pk_bf16_f32 v104, v104, v105
  v_and_b32 v105, 0xffff0000, v104
  v_lshlrev_b32 v104, 16, v104
  v_add_f32 v104, v104, v105
  v_add_f32 v96, v96, v104
  s_waitcnt vmcnt(2)
  v_lshlrev_b32 v98, 16, v84
  v_and_b32 v99, 0xffff0000, v84
  v_pk_mul_f32 v[98:99], v[98:99], v[24:25]
  v_cvt_pk_bf16_f32 v98, v98, v99
  v_and_b32 v99, 0xffff0000, v98
  v_lshlrev_b32 v98, 16, v98
  v_add_f32 v98, v98, v99
  v_add_f32 v96, v96, v98
  v_lshlrev_b32 v100, 16, v85
  v_and_b32 v101, 0xffff0000, v85
  v_pk_mul_f32 v[100:101], v[100:101], v[26:27]
  v_cvt_pk_bf16_f32 v100, v100, v101
  v_and_b32 v101, 0xffff0000, v100
  v_lshlrev_b32 v100, 16, v100
  v_add_f32 v100, v100, v101
  v_add_f32 v96, v96, v100
  v_lshlrev_b32 v102, 16, v86
  v_and_b32 v103, 0xffff0000, v86
  v_pk_mul_f32 v[102:103], v[102:103], v[28:29]
  v_cvt_pk_bf16_f32 v102, v102, v103
  v_and_b32 v103, 0xffff0000, v102
  v_lshlrev_b32 v102, 16, v102
  v_add_f32 v102, v102, v103
  v_add_f32 v96, v96, v102
  v_lshlrev_b32 v104, 16, v87
  v_and_b32 v105, 0xffff0000, v87
  v_pk_mul_f32 v[104:105], v[104:105], v[30:31]
  v_cvt_pk_bf16_f32 v104, v104, v105
  v_and_b32 v105, 0xffff0000, v104
  v_lshlrev_b32 v104, 16, v104
  v_add_f32 v104, v104, v105
  v_add_f32 v96, v96, v104
  s_nop 1
  v_add_f32_dpp v96, v96, v96 row_ror:8 row_mask:0xf bank_mask:0xf
  s_nop 1
  v_add_f32_dpp v96, v96, v96 row_ror:4 row_mask:0xf bank_mask:0xf
  s_nop 1
  v_add_f32_dpp v96, v96, v96 row_ror:2 row_mask:0xf bank_mask:0xf
  s_nop 1
  v_add_f32_dpp v96, v96, v96 row_ror:1 row_mask:0xf bank_mask:0xf
  v_mov_b32 v97, v96
  s_nop 1
  v_permlane16_swap_b32 v96, v97
  v_add_f32 v96, v96, v97
  v_cvt_pk_bf16_f32 v96, v96, v96
  v_lshlrev_b32 v96, 16, v96
  v_mul_f32 v96, 0xbfb8aa3b, v96
  v_exp_f32 v96, v96
  s_nop 0
  v_add_f32 v96, 1.0, v96
  v_rcp_f32 v96, v96
  s_nop 0
  v_cvt_pk_bf16_f32 v96, v96, v96
  v_lshlrev_b32 v80, 16, v96
  v_sub_f32 v81, 1.0, v80
  v_cvt_pk_bf16_f32 v81, v81, v81
  v_lshlrev_b32 v81, 16, v81
  s_waitcnt vmcnt(1)
  v_lshlrev_b32 v98, 16, v88
  v_and_b32 v99, 0xffff0000, v88
  v_pk_mul_f32 v[98:99], v[98:99], v[16:17]
  v_cvt_pk_bf16_f32 v98, v98, v99
  v_and_b32 v99, 0xffff0000, v98
  v_lshlrev_b32 v98, 16, v98
  v_add_f32 v96, v98, v99
  v_lshlrev_b32 v100, 16, v89
  v_and_b32 v101, 0xffff0000, v89
  v_pk_mul_f32 v[100:101], v[100:101], v[18:19]
  v_cvt_pk_bf16_f32 v100, v100, v101
  v_and_b32 v101, 0xffff0000, v100
  v_lshlrev_b32 v100, 16, v100
  v_add_f32 v100, v100, v101
  v_add_f32 v96, v96, v100
  v_lshlrev_b32 v102, 16, v90
  v_and_b32 v103, 0xffff0000, v90
  v_pk_mul_f32 v[102:103], v[102:103], v[20:21]
  v_cvt_pk_bf16_f32 v102, v102, v103
  v_and_b32 v103, 0xffff0000, v102
  v_lshlrev_b32 v102, 16, v102
  v_add_f32 v102, v102, v103
  v_add_f32 v96, v96, v102
  v_lshlrev_b32 v104, 16, v91
  v_and_b32 v105, 0xffff0000, v91
  v_pk_mul_f32 v[104:105], v[104:105], v[22:23]
  v_cvt_pk_bf16_f32 v104, v104, v105
  v_and_b32 v105, 0xffff0000, v104
  v_lshlrev_b32 v104, 16, v104
  v_add_f32 v104, v104, v105
  v_add_f32 v96, v96, v104
  s_waitcnt vmcnt(0)
  v_lshlrev_b32 v98, 16, v92
  v_and_b32 v99, 0xffff0000, v92
  v_pk_mul_f32 v[98:99], v[98:99], v[24:25]
  v_cvt_pk_bf16_f32 v98, v98, v99
  v_and_b32 v99, 0xffff0000, v98
  v_lshlrev_b32 v98, 16, v98
  v_add_f32 v98, v98, v99
  v_add_f32 v96, v96, v98
  v_lshlrev_b32 v100, 16, v93
  v_and_b32 v101, 0xffff0000, v93
  v_pk_mul_f32 v[100:101], v[100:101], v[26:27]
  v_cvt_pk_bf16_f32 v100, v100, v101
  v_and_b32 v101, 0xffff0000, v100
  v_lshlrev_b32 v100, 16, v100
  v_add_f32 v100, v100, v101
  v_add_f32 v96, v96, v100
  v_lshlrev_b32 v102, 16, v94
  v_and_b32 v103, 0xffff0000, v94
  v_pk_mul_f32 v[102:103], v[102:103], v[28:29]
  v_cvt_pk_bf16_f32 v102, v102, v103
  v_and_b32 v103, 0xffff0000, v102
  v_lshlrev_b32 v102, 16, v102
  v_add_f32 v102, v102, v103
  v_add_f32 v96, v96, v102
  v_lshlrev_b32 v104, 16, v95
  v_and_b32 v105, 0xffff0000, v95
  v_pk_mul_f32 v[104:105], v[104:105], v[30:31]
  v_cvt_pk_bf16_f32 v104, v104, v105
  v_and_b32 v105, 0xffff0000, v104
  v_lshlrev_b32 v104, 16, v104
  v_add_f32 v104, v104, v105
  v_add_f32 v96, v96, v104
  s_nop 1
  v_add_f32_dpp v96, v96, v96 row_ror:8 row_mask:0xf bank_mask:0xf
  s_nop 1
  v_add_f32_dpp v96, v96, v96 row_ror:4 row_mask:0xf bank_mask:0xf
  s_nop 1
  v_add_f32_dpp v96, v96, v96 row_ror:2 row_mask:0xf bank_mask:0xf
  s_nop 1
  v_add_f32_dpp v96, v96, v96 row_ror:1 row_mask:0xf bank_mask:0xf
  v_mov_b32 v97, v96
  s_nop 1
  v_permlane16_swap_b32 v96, v97
  v_add_f32 v96, v96, v97
  v_cvt_pk_bf16_f32 v96, v96, v96
  v_lshlrev_b32 v96, 16, v96
  v_mul_f32 v96, 0xbfb8aa3b, v96
  v_exp_f32 v96, v96
  s_nop 0
  v_add_f32 v96, 1.0, v96
  v_rcp_f32 v96, v96
  s_nop 0
  v_cvt_pk_bf16_f32 v96, v96, v96
  v_lshlrev_b32 v88, 16, v96
  v_sub_f32 v89, 1.0, v88
  v_cvt_pk_bf16_f32 v89, v89, v89
  v_lshlrev_b32 v89, 16, v89
  v_cmp_eq_u32 vcc, 0, v123
  s_nop 0
  s_and_saveexec_b64 s[88:89], vcc
  global_store_dwordx2 v122, v[32:33], s[34:35] offset:0 sc0 sc1
  global_store_dwordx2 v122, v[40:41], s[34:35] offset:16 sc0 sc1
  global_store_dwordx2 v122, v[48:49], s[34:35] offset:32 sc0 sc1
  global_store_dwordx2 v122, v[56:57], s[34:35] offset:48 sc0 sc1
  global_store_dwordx2 v122, v[64:65], s[34:35] offset:64 sc0 sc1
  global_store_dwordx2 v122, v[72:73], s[34:35] offset:80 sc0 sc1
  global_store_dwordx2 v122, v[80:81], s[34:35] offset:96 sc0 sc1
  global_store_dwordx2 v122, v[88:89], s[34:35] offset:112 sc0 sc1
  s_mov_b64 exec, s[88:89]
L_p2_F:
  s_waitcnt vmcnt(0) lgkmcnt(0)
  s_barrier
  s_setprio 0
  s_lshr_b32 s72, s63, 3
  s_and_b32 s73, s63, 7
  s_mov_b32 s40, s26
  s_mov_b32 s41, s27
  s_mov_b32 s42, 1835008
  s_mov_b32 s43, 0x20000
  v_bfe_u32 v24, v1, 4, 1
  v_lshlrev_b32 v24, 2, v24
  v_and_b32 v25, 7, v1
  v_xor_b32 v24, v24, v25
  v_lshlrev_b32 v24, 4, v24
  v_lshrrev_b32 v25, 3, v1
  v_lshlrev_b32 v25, 10, v25
  v_add_u32 v6, v24, v25
  v_add_u32 v7, 7168, v6
  s_lshl_b32 s68, s72, 2
  s_add_u32 s68, s68, s61
  s_mul_i32 s76, s68, 229376
  s_lshl_b32 s68, s73, 7
  s_add_u32 s76, s76, s68
  s_lshl_b32 s75, s61, 14
  s_mov_b32 s48, 0
  s_mov_b32 s49, 1024
  s_mov_b32 s50, 2048
  s_mov_b32 s51, 3072
  s_mov_b32 s52, 4096
  s_mov_b32 s53, 5120
  s_mov_b32 s54, 6144
  s_mov_b32 s55, 7168
  s_mov_b32 s77, 8192
  s_mov_b32 s78, 9216
  s_mov_b32 s79, 10240
  s_mov_b32 s80, 11264
  s_mov_b32 s81, 12288
  s_mov_b32 s82, 13312
  s_add_u32 m0, s75, 0
  s_lshl_b32 s69, s77, 4
  s_add_u32 s69, s69, s76
  buffer_load_dwordx4 v6, s[40:43], s69 offen lds
  buffer_load_dwordx4 v7, s[40:43], s69 offen offset:1024 lds
  s_add_u32 m0, s75, 2048
  s_lshl_b32 s69, s78, 4
  s_add_u32 s69, s69, s76
  buffer_load_dwordx4 v6, s[40:43], s69 offen lds
  buffer_load_dwordx4 v7, s[40:43], s69 offen offset:1024 lds
  s_add_u32 m0, s75, 4096
  s_lshl_b32 s69, s79, 4
  s_add_u32 s69, s69, s76
  buffer_load_dwordx4 v6, s[40:43], s69 offen lds
  buffer_load_dwordx4 v7, s[40:43], s69 offen offset:1024 lds
  s_add_u32 m0, s75, 6144
  s_lshl_b32 s69, s80, 4
  s_add_u32 s69, s69, s76
  buffer_load_dwordx4 v6, s[40:43], s69 offen lds
  buffer_load_dwordx4 v7, s[40:43], s69 offen offset:1024 lds
  s_add_u32 m0, s75, 8192
  s_lshl_b32 s69, s81, 4
  s_add_u32 s69, s69, s76
  buffer_load_dwordx4 v6, s[40:43], s69 offen lds
  buffer_load_dwordx4 v7, s[40:43], s69 offen offset:1024 lds
  s_add_u32 m0, s75, 10240
  s_lshl_b32 s69, s82, 4
  s_add_u32 s69, s69, s76
  buffer_load_dwordx4 v6, s[40:43], s69 offen lds
  buffer_load_dwordx4 v7, s[40:43], s69 offen offset:1024 lds
  v_lshrrev_b32 v24, 5, v1
  v_mul_u32_u24 v24, 4, v24
  v_bfe_u32 v25, v1, 2, 2
  v_add_u32 v24, v24, v25
  v_lshlrev_b32 v24, 7, v24
  v_bfe_u32 v25, v1, 3, 1
  v_lshlrev_b32 v25, 6, v25
  v_bfe_u32 v26, v1, 4, 1
  v_lshlrev_b32 v26, 5, v26
  v_and_b32 v27, 3, v1
  v_lshlrev_b32 v27, 3, v27
  v_add3_u32 v24, v24, v26, v27
  v_add_u32 v20, v24, v25
  v_xor_b32 v25, 64, v25
  v_add_u32 v21, v24, v25
  s_lshl_b32 s70, s61, 13
  s_add_u32 s70, s70, 98304
  v_add_u32 v28, s70, v20
  v_add_u32 v29, s70, v21
  ds_read_b64_tr_b16 a[0:1], v28 offset:0
  ds_read_b64_tr_b16 a[2:3], v28 offset:1024
  ds_read_b64_tr_b16 a[4:5], v29 offset:0
  ds_read_b64_tr_b16 a[6:7], v29 offset:1024
  ds_read_b64_tr_b16 a[8:9], v28 offset:2048
  ds_read_b64_tr_b16 a[10:11], v28 offset:3072
  ds_read_b64_tr_b16 a[12:13], v29 offset:2048
  ds_read_b64_tr_b16 a[14:15], v29 offset:3072
  ds_read_b64_tr_b16 a[16:17], v28 offset:4096
  ds_read_b64_tr_b16 a[18:19], v28 offset:5120
  ds_read_b64_tr_b16 a[20:21], v29 offset:4096
  ds_read_b64_tr_b16 a[22:23], v29 offset:5120
  ds_read_b64_tr_b16 a[24:25], v28 offset:6144
  ds_read_b64_tr_b16 a[26:27], v28 offset:7168
  ds_read_b64_tr_b16 a[28:29], v29 offset:6144
  ds_read_b64_tr_b16 a[30:31], v29 offset:7168
  ds_read_b64_tr_b16 a[32:33], v28 offset:32768
  ds_read_b64_tr_b16 a[34:35], v28 offset:33792
  ds_read_b64_tr_b16 a[36:37], v29 offset:32768
  ds_read_b64_tr_b16 a[38:39], v29 offset:33792
  ds_read_b64_tr_b16 a[40:41], v28 offset:34816
  ds_read_b64_tr_b16 a[42:43], v28 offset:35840
  ds_read_b64_tr_b16 a[44:45], v29 offset:34816
  ds_read_b64_tr_b16 a[46:47], v29 offset:35840
  ds_read_b64_tr_b16 a[48:49], v28 offset:36864
  ds_read_b64_tr_b16 a[50:51], v28 offset:37888
  ds_read_b64_tr_b16 a[52:53], v29 offset:36864
  ds_read_b64_tr_b16 a[54:55], v29 offset:37888
  ds_read_b64_tr_b16 a[56:57], v28 offset:38912
  ds_read_b64_tr_b16 a[58:59], v28 offset:39936
  ds_read_b64_tr_b16 a[60:61], v29 offset:38912
  ds_read_b64_tr_b16 a[62:63], v29 offset:39936
  v_add_u32 v20, s75, v20
  v_add_u32 v21, s75, v21
  v_mov_b32 v22, v6
  v_mov_b32 v23, v7
  s_mov_b32 s36, s34
  s_mov_b32 s37, s35
  s_mov_b32 s38, 19022080
  s_mov_b32 s39, 0x20000
  s_xor_b32 s68, s72, 1
  s_lshl_b32 s68, s68, 1
  s_lshl_b32 s69, s62, 2
  s_add_u32 s68, s68, s69
  s_mul_i32 s68, s68, 180224
  v_lshlrev_b32 v6, 4, v1
  v_add_u32 v2, s68, v6
  v_add_u32 v3, 180224, v2
  s_lshl_b32 s68, s72, 2
  s_sub_u32 s68, s68, 2
  s_mul_i32 s68, s68, 180224
  v_add_u32 v4, s68, v2
  v_add_u32 v5, s68, v3
  s_lshl_b32 s74, s72, 2
  s_add_u32 s74, s74, s61
  s_mul_i32 s74, s74, 14336
  s_add_u32 s74, s74, 65536
  s_waitcnt lgkmcnt(0)
  s_barrier
  s_add_u32 s68, s74, s48
  buffer_load_dwordx4 v[24:27], v2, s[36:39], s68 offen sc1
  buffer_load_dwordx4 v[28:31], v3, s[36:39], s68 offen sc1
  s_add_u32 s68, s74, s49
  buffer_load_dwordx4 v[32:35], v2, s[36:39], s68 offen sc1
  buffer_load_dwordx4 v[36:39], v3, s[36:39], s68 offen sc1
  s_add_u32 s68, s74, s50
  buffer_load_dwordx4 v[40:43], v2, s[36:39], s68 offen sc1
  buffer_load_dwordx4 v[44:47], v3, s[36:39], s68 offen sc1
  s_add_u32 s68, s74, s51
  buffer_load_dwordx4 v[48:51], v2, s[36:39], s68 offen sc1
  buffer_load_dwordx4 v[52:55], v3, s[36:39], s68 offen sc1
  v_bfe_u32 v6, v1, 3, 2
  v_and_b32 v7, 7, v1
  v_lshl_add_u32 v8, v7, 2, v6
  s_xor_b32 s68, s72, 1
  s_lshl_b32 s68, s68, 6
  s_lshl_b32 s69, s62, 7
  s_add_u32 s68, s68, s69
  v_add_u32 v6, s68, v8
  v_lshlrev_b32 v6, 3, v6
  v_add_u32 v6, 14417924, v6
  global_load_dword v10, v6, s[34:35] sc1
  global_load_dword v11, v6, s[34:35] offset:256 sc1
  s_lshl_b32 s68, s72, 7
  s_sub_u32 s68, s68, 64
  s_lshl_b32 s68, s68, 3
  v_add_u32 v6, s68, v6
  global_load_dword v12, v6, s[34:35] sc1
  global_load_dword v13, v6, s[34:35] offset:256 sc1
  s_lshl_b32 s68, s61, 14
  v_lshlrev_b32 v9, 8, v8
  v_add_u32 v9, s68, v9
  v_lshrrev_b32 v6, 5, v1
  v_and_b32 v7, 7, v1
  v_xor_b32 v6, v6, v7
  v_xor_b32 v7, 0, v6
  v_lshl_add_u32 v16, v7, 4, v9
  v_xor_b32 v7, 2, v6
  v_lshl_add_u32 v17, v7, 4, v9
  v_xor_b32 v7, 4, v6
  v_lshl_add_u32 v18, v7, 4, v9
  v_xor_b32 v7, 6, v6
  v_lshl_add_u32 v19, v7, 4, v9
  s_add_u32 s68, s74, s52
  buffer_load_dwordx4 v[56:59], v2, s[36:39], s68 offen sc1
  buffer_load_dwordx4 v[60:63], v3, s[36:39], s68 offen sc1
  s_add_u32 s68, s74, s53
  buffer_load_dwordx4 a[112:115], v2, s[36:39], s68 offen sc1
  buffer_load_dwordx4 a[116:119], v3, s[36:39], s68 offen sc1
  s_add_u32 s68, s74, s54
  buffer_load_dwordx4 a[120:123], v2, s[36:39], s68 offen sc1
  buffer_load_dwordx4 a[124:127], v3, s[36:39], s68 offen sc1
  s_waitcnt vmcnt(17)
  v_mfma_f32_32x32x16_bf16 v[64:79], a[0:3], v[24:27], 0
  s_waitcnt vmcnt(16)
  v_mfma_f32_32x32x16_bf16 v[80:95], a[0:3], v[28:31], 0
  v_mfma_f32_32x32x16_bf16 v[96:111], a[4:7], v[24:27], 0
  s_add_u32 s68, s74, s55
  buffer_load_dwordx4 v[24:27], v2, s[36:39], s68 offen sc1
  v_mfma_f32_32x32x16_bf16 v[112:127], a[4:7], v[28:31], 0
  buffer_load_dwordx4 v[28:31], v3, s[36:39], s68 offen sc1
  s_waitcnt vmcnt(17)
  v_mfma_f32_32x32x16_bf16 v[64:79], a[8:11], v[32:35], v[64:79]
  s_waitcnt vmcnt(16)
  v_mfma_f32_32x32x16_bf16 v[80:95], a[8:11], v[36:39], v[80:95]
  v_mfma_f32_32x32x16_bf16 v[96:111], a[12:15], v[32:35], v[96:111]
  s_add_u32 s68, s74, s77
  buffer_load_dwordx4 v[32:35], v2, s[36:39], s68 offen sc1
  v_mfma_f32_32x32x16_bf16 v[112:127], a[12:15], v[36:39], v[112:127]
  buffer_load_dwordx4 v[36:39], v3, s[36:39], s68 offen sc1
  s_waitcnt vmcnt(17)
  v_mfma_f32_32x32x16_bf16 v[64:79], a[16:19], v[40:43], v[64:79]
  s_waitcnt vmcnt(16)
  v_mfma_f32_32x32x16_bf16 v[80:95], a[16:19], v[44:47], v[80:95]
  v_mfma_f32_32x32x16_bf16 v[96:111], a[20:23], v[40:43], v[96:111]
  s_add_u32 s68, s74, s78
  buffer_load_dwordx4 v[40:43], v2, s[36:39], s68 offen sc1
  v_mfma_f32_32x32x16_bf16 v[112:127], a[20:23], v[44:47], v[112:127]
  buffer_load_dwordx4 v[44:47], v3, s[36:39], s68 offen sc1
  s_waitcnt vmcnt(17)
  v_mfma_f32_32x32x16_bf16 v[64:79], a[24:27], v[48:51], v[64:79]
  s_waitcnt vmcnt(16)
  v_mfma_f32_32x32x16_bf16 v[80:95], a[24:27], v[52:55], v[80:95]
  v_mfma_f32_32x32x16_bf16 v[96:111], a[28:31], v[48:51], v[96:111]
  s_add_u32 s68, s74, s79
  buffer_load_dwordx4 v[48:51], v2, s[36:39], s68 offen sc1
  v_mfma_f32_32x32x16_bf16 v[112:127], a[28:31], v[52:55], v[112:127]
  buffer_load_dwordx4 v[52:55], v3, s[36:39], s68 offen sc1
  s_waitcnt vmcnt(13)
  v_mfma_f32_32x32x16_bf16 v[64:79], a[32:35], v[56:59], v[64:79]
  s_waitcnt vmcnt(12)
  v_mfma_f32_32x32x16_bf16 v[80:95], a[32:35], v[60:63], v[80:95]
  v_mfma_f32_32x32x16_bf16 v[96:111], a[36:39], v[56:59], v[96:111]
  s_add_u32 s68, s74, s80
  buffer_load_dwordx4 v[56:59], v2, s[36:39], s68 offen sc1
  v_mfma_f32_32x32x16_bf16 v[112:127], a[36:39], v[60:63], v[112:127]
  buffer_load_dwordx4 v[60:63], v3, s[36:39], s68 offen sc1
  s_waitcnt vmcnt(13)
  v_mfma_f32_32x32x16_bf16 v[64:79], a[40:43], a[112:115], v[64:79]
  s_waitcnt vmcnt(12)
  v_mfma_f32_32x32x16_bf16 v[80:95], a[40:43], a[116:119], v[80:95]
  v_mfma_f32_32x32x16_bf16 v[96:111], a[44:47], a[112:115], v[96:111]
  s_add_u32 s68, s74, s81
  buffer_load_dwordx4 a[112:115], v2, s[36:39], s68 offen sc1
  v_mfma_f32_32x32x16_bf16 v[112:127], a[44:47], a[116:119], v[112:127]
  buffer_load_dwordx4 a[116:119], v3, s[36:39], s68 offen sc1
  s_waitcnt vmcnt(13)
  v_mfma_f32_32x32x16_bf16 v[64:79], a[48:51], a[120:123], v[64:79]
  s_waitcnt vmcnt(12)
  v_mfma_f32_32x32x16_bf16 v[80:95], a[48:51], a[124:127], v[80:95]
  ds_read_b64_tr_b16 a[64:65], v20 offset:0
  ds_read_b64_tr_b16 a[66:67], v20 offset:1024
  ds_read_b64_tr_b16 a[68:69], v21 offset:0
  ds_read_b64_tr_b16 a[70:71], v21 offset:1024
  v_mfma_f32_32x32x16_bf16 v[96:111], a[52:55], a[120:123], v[96:111]
  s_add_u32 s68, s74, s82
  buffer_load_dwordx4 a[120:123], v2, s[36:39], s68 offen sc1
  v_mfma_f32_32x32x16_bf16 v[112:127], a[52:55], a[124:127], v[112:127]
  buffer_load_dwordx4 a[124:127], v3, s[36:39], s68 offen sc1
  s_barrier
  s_waitcnt vmcnt(13)
  v_mfma_f32_32x32x16_bf16 v[64:79], a[56:59], v[24:27], v[64:79]
  s_waitcnt vmcnt(12)
  v_mfma_f32_32x32x16_bf16 v[80:95], a[56:59], v[28:31], v[80:95]
  ds_read_b64_tr_b16 a[72:73], v20 offset:2048
  ds_read_b64_tr_b16 a[74:75], v20 offset:3072
  ds_read_b64_tr_b16 a[76:77], v21 offset:2048
  ds_read_b64_tr_b16 a[78:79], v21 offset:3072
  v_mfma_f32_32x32x16_bf16 v[96:111], a[60:63], v[24:27], v[96:111]
  v_mfma_f32_32x32x16_bf16 v[112:127], a[60:63], v[28:31], v[112:127]
  s_waitcnt lgkmcnt(4)
  s_waitcnt vmcnt(11)
  v_mfma_f32_32x32x16_bf16 v[64:79], a[64:67], v[32:35], v[64:79]
  s_waitcnt vmcnt(10)
  v_mfma_f32_32x32x16_bf16 v[80:95], a[64:67], v[36:39], v[80:95]
  ds_read_b64_tr_b16 a[80:81], v20 offset:4096
  ds_read_b64_tr_b16 a[82:83], v20 offset:5120
  ds_read_b64_tr_b16 a[84:85], v21 offset:4096
  ds_read_b64_tr_b16 a[86:87], v21 offset:5120
  v_mfma_f32_32x32x16_bf16 v[96:111], a[68:71], v[32:35], v[96:111]
  v_mfma_f32_32x32x16_bf16 v[112:127], a[68:71], v[36:39], v[112:127]
  s_waitcnt lgkmcnt(4)
  s_waitcnt vmcnt(9)
  v_mfma_f32_32x32x16_bf16 v[64:79], a[72:75], v[40:43], v[64:79]
  s_waitcnt vmcnt(8)
  v_mfma_f32_32x32x16_bf16 v[80:95], a[72:75], v[44:47], v[80:95]
  ds_read_b64_tr_b16 a[88:89], v20 offset:6144
  ds_read_b64_tr_b16 a[90:91], v20 offset:7168
  ds_read_b64_tr_b16 a[92:93], v21 offset:6144
  ds_read_b64_tr_b16 a[94:95], v21 offset:7168
  v_mfma_f32_32x32x16_bf16 v[96:111], a[76:79], v[40:43], v[96:111]
  v_mfma_f32_32x32x16_bf16 v[112:127], a[76:79], v[44:47], v[112:127]
  s_waitcnt lgkmcnt(4)
  s_waitcnt vmcnt(7)
  v_mfma_f32_32x32x16_bf16 v[64:79], a[80:83], v[48:51], v[64:79]
  s_waitcnt vmcnt(6)
  v_mfma_f32_32x32x16_bf16 v[80:95], a[80:83], v[52:55], v[80:95]
  ds_read_b64_tr_b16 a[96:97], v20 offset:8192
  ds_read_b64_tr_b16 a[98:99], v20 offset:9216
  ds_read_b64_tr_b16 a[100:101], v21 offset:8192
  ds_read_b64_tr_b16 a[102:103], v21 offset:9216
  v_mfma_f32_32x32x16_bf16 v[96:111], a[84:87], v[48:51], v[96:111]
  v_mfma_f32_32x32x16_bf16 v[112:127], a[84:87], v[52:55], v[112:127]
  s_waitcnt lgkmcnt(4)
  s_waitcnt vmcnt(5)
  v_mfma_f32_32x32x16_bf16 v[64:79], a[88:91], v[56:59], v[64:79]
  s_waitcnt vmcnt(4)
  v_mfma_f32_32x32x16_bf16 v[80:95], a[88:91], v[60:63], v[80:95]
  ds_read_b64_tr_b16 a[104:105], v20 offset:10240
  ds_read_b64_tr_b16 a[106:107], v20 offset:11264
  ds_read_b64_tr_b16 a[108:109], v21 offset:10240
  ds_read_b64_tr_b16 a[110:111], v21 offset:11264
  v_mfma_f32_32x32x16_bf16 v[96:111], a[92:95], v[56:59], v[96:111]
  v_mfma_f32_32x32x16_bf16 v[112:127], a[92:95], v[60:63], v[112:127]
  s_waitcnt lgkmcnt(4)
  s_waitcnt vmcnt(3)
  v_mfma_f32_32x32x16_bf16 v[64:79], a[96:99], a[112:115], v[64:79]
  s_waitcnt vmcnt(2)
  v_mfma_f32_32x32x16_bf16 v[80:95], a[96:99], a[116:119], v[80:95]
  v_mfma_f32_32x32x16_bf16 v[96:111], a[100:103], a[112:115], v[96:111]
  v_mfma_f32_32x32x16_bf16 v[112:127], a[100:103], a[116:119], v[112:127]
  s_waitcnt lgkmcnt(0)
  s_waitcnt vmcnt(1)
  v_mfma_f32_32x32x16_bf16 v[64:79], a[104:107], a[120:123], v[64:79]
  s_waitcnt vmcnt(0)
  v_mfma_f32_32x32x16_bf16 v[80:95], a[104:107], a[124:127], v[80:95]
  v_mfma_f32_32x32x16_bf16 v[96:111], a[108:111], a[120:123], v[96:111]
  s_add_u32 s68, s74, s48
  buffer_load_dwordx4 v[24:27], v4, s[36:39], s68 offen sc1
  v_mfma_f32_32x32x16_bf16 v[112:127], a[108:111], a[124:127], v[112:127]
  buffer_load_dwordx4 v[28:31], v5, s[36:39], s68 offen sc1
  s_nop 4
  v_mul_f32 v64, v10, v64
  v_mul_f32 v65, v10, v65
  v_mul_f32 v66, v10, v66
  v_mul_f32 v67, v10, v67
  v_mul_f32 v68, v10, v68
  v_mul_f32 v69, v10, v69
  s_add_u32 s68, s74, s49
  buffer_load_dwordx4 v[32:35], v4, s[36:39], s68 offen sc1
  v_mul_f32 v70, v10, v70
  v_mul_f32 v71, v10, v71
  v_mul_f32 v72, v10, v72
  v_mul_f32 v73, v10, v73
  v_mul_f32 v74, v10, v74
  v_mul_f32 v75, v10, v75
  buffer_load_dwordx4 v[36:39], v5, s[36:39], s68 offen sc1
  v_mul_f32 v76, v10, v76
  v_mul_f32 v77, v10, v77
  v_mul_f32 v78, v10, v78
  v_mul_f32 v79, v10, v79
  ds_write_b128 v16, v[64:67] offset:0
  ds_write_b128 v17, v[68:71] offset:0
  s_add_u32 s68, s74, s50
  buffer_load_dwordx4 v[40:43], v4, s[36:39], s68 offen sc1
  ds_write_b128 v18, v[72:75] offset:0
  ds_write_b128 v19, v[76:79] offset:0
  v_mul_f32 v80, v11, v80
  v_mul_f32 v81, v11, v81
  v_mul_f32 v82, v11, v82
  v_mul_f32 v83, v11, v83
  buffer_load_dwordx4 v[44:47], v5, s[36:39], s68 offen sc1
  v_mul_f32 v84, v11, v84
  v_mul_f32 v85, v11, v85
  v_mul_f32 v86, v11, v86
  v_mul_f32 v87, v11, v87
  v_mul_f32 v88, v11, v88
  v_mul_f32 v89, v11, v89
  s_add_u32 s68, s74, s51
  buffer_load_dwordx4 v[48:51], v4, s[36:39], s68 offen sc1
  v_mul_f32 v90, v11, v90
  v_mul_f32 v91, v11, v91
  v_mul_f32 v92, v11, v92
  v_mul_f32 v93, v11, v93
  v_mul_f32 v94, v11, v94
  v_mul_f32 v95, v11, v95
  buffer_load_dwordx4 v[52:55], v5, s[36:39], s68 offen sc1
  ds_write_b128 v16, v[80:83] offset:8192
  ds_write_b128 v17, v[84:87] offset:8192
  ds_write_b128 v18, v[88:91] offset:8192
  ds_write_b128 v19, v[92:95] offset:8192
  v_mul_f32 v96, v10, v96
  v_mul_f32 v97, v10, v97
  s_add_u32 s68, s74, s52
  buffer_load_dwordx4 v[56:59], v4, s[36:39], s68 offen sc1
  v_mul_f32 v98, v10, v98
  v_mul_f32 v99, v10, v99
  v_mul_f32 v100, v10, v100
  v_mul_f32 v101, v10, v101
  v_mul_f32 v102, v10, v102
  v_mul_f32 v103, v10, v103
  buffer_load_dwordx4 v[60:63], v5, s[36:39], s68 offen sc1
  v_mul_f32 v104, v10, v104
  v_mul_f32 v105, v10, v105
  v_mul_f32 v106, v10, v106
  v_mul_f32 v107, v10, v107
  v_mul_f32 v108, v10, v108
  v_mul_f32 v109, v10, v109
  s_add_u32 s68, s74, s53
  buffer_load_dwordx4 a[112:115], v4, s[36:39], s68 offen sc1
  v_mul_f32 v110, v10, v110
  v_mul_f32 v111, v10, v111
  ds_write_b128 v16, v[96:99] offset:128
  ds_write_b128 v17, v[100:103] offset:128
  ds_write_b128 v18, v[104:107] offset:128
  ds_write_b128 v19, v[108:111] offset:128
  buffer_load_dwordx4 a[116:119], v5, s[36:39], s68 offen sc1
  v_mul_f32 v112, v11, v112
  v_mul_f32 v113, v11, v113
  v_mul_f32 v114, v11, v114
  v_mul_f32 v115, v11, v115
  v_mul_f32 v116, v11, v116
  v_mul_f32 v117, v11, v117
  s_add_u32 s68, s74, s54
  buffer_load_dwordx4 a[120:123], v4, s[36:39], s68 offen sc1
  v_mul_f32 v118, v11, v118
  v_mul_f32 v119, v11, v119
  v_mul_f32 v120, v11, v120
  v_mul_f32 v121, v11, v121
  v_mul_f32 v122, v11, v122
  v_mul_f32 v123, v11, v123
  buffer_load_dwordx4 a[124:127], v5, s[36:39], s68 offen sc1
  v_mul_f32 v124, v11, v124
  v_mul_f32 v125, v11, v125
  v_mul_f32 v126, v11, v126
  v_mul_f32 v127, v11, v127
  ds_write_b128 v16, v[112:115] offset:8320
  ds_write_b128 v17, v[116:119] offset:8320
  ds_write_b128 v18, v[120:123] offset:8320
  ds_write_b128 v19, v[124:127] offset:8320
  s_waitcnt lgkmcnt(0)
  s_barrier
  s_waitcnt vmcnt(13)
  v_mfma_f32_32x32x16_bf16 v[64:79], a[0:3], v[24:27], 0
  s_waitcnt vmcnt(12)
  v_mfma_f32_32x32x16_bf16 v[80:95], a[0:3], v[28:31], 0
  v_mfma_f32_32x32x16_bf16 v[96:111], a[4:7], v[24:27], 0
  s_add_u32 s68, s74, s55
  buffer_load_dwordx4 v[24:27], v4, s[36:39], s68 offen sc1
  v_mfma_f32_32x32x16_bf16 v[112:127], a[4:7], v[28:31], 0
  buffer_load_dwordx4 v[28:31], v5, s[36:39], s68 offen sc1
  s_waitcnt vmcnt(13)
  v_mfma_f32_32x32x16_bf16 v[64:79], a[8:11], v[32:35], v[64:79]
  s_waitcnt vmcnt(12)
  v_mfma_f32_32x32x16_bf16 v[80:95], a[8:11], v[36:39], v[80:95]
  v_mfma_f32_32x32x16_bf16 v[96:111], a[12:15], v[32:35], v[96:111]
  s_add_u32 s68, s74, s77
  buffer_load_dwordx4 v[32:35], v4, s[36:39], s68 offen sc1
  v_mfma_f32_32x32x16_bf16 v[112:127], a[12:15], v[36:39], v[112:127]
  buffer_load_dwordx4 v[36:39], v5, s[36:39], s68 offen sc1
  s_waitcnt vmcnt(13)
  v_mfma_f32_32x32x16_bf16 v[64:79], a[16:19], v[40:43], v[64:79]
  s_waitcnt vmcnt(12)
  v_mfma_f32_32x32x16_bf16 v[80:95], a[16:19], v[44:47], v[80:95]
  v_mfma_f32_32x32x16_bf16 v[96:111], a[20:23], v[40:43], v[96:111]
  s_add_u32 s68, s74, s78
  buffer_load_dwordx4 v[40:43], v4, s[36:39], s68 offen sc1
  v_mfma_f32_32x32x16_bf16 v[112:127], a[20:23], v[44:47], v[112:127]
  buffer_load_dwordx4 v[44:47], v5, s[36:39], s68 offen sc1
  s_waitcnt vmcnt(13)
  v_mfma_f32_32x32x16_bf16 v[64:79], a[24:27], v[48:51], v[64:79]
  s_waitcnt vmcnt(12)
  v_mfma_f32_32x32x16_bf16 v[80:95], a[24:27], v[52:55], v[80:95]
  v_mfma_f32_32x32x16_bf16 v[96:111], a[28:31], v[48:51], v[96:111]
  s_add_u32 s68, s74, s79
  buffer_load_dwordx4 v[48:51], v4, s[36:39], s68 offen sc1
  v_mfma_f32_32x32x16_bf16 v[112:127], a[28:31], v[52:55], v[112:127]
  buffer_load_dwordx4 v[52:55], v5, s[36:39], s68 offen sc1
  s_barrier
  s_waitcnt vmcnt(13)
  v_mfma_f32_32x32x16_bf16 v[64:79], a[32:35], v[56:59], v[64:79]
  s_waitcnt vmcnt(12)
  v_mfma_f32_32x32x16_bf16 v[80:95], a[32:35], v[60:63], v[80:95]
  v_mfma_f32_32x32x16_bf16 v[96:111], a[36:39], v[56:59], v[96:111]
  s_add_u32 s68, s74, s80
  buffer_load_dwordx4 v[56:59], v4, s[36:39], s68 offen sc1
  v_mfma_f32_32x32x16_bf16 v[112:127], a[36:39], v[60:63], v[112:127]
  buffer_load_dwordx4 v[60:63], v5, s[36:39], s68 offen sc1
  s_waitcnt vmcnt(13)
  v_mfma_f32_32x32x16_bf16 v[64:79], a[40:43], a[112:115], v[64:79]
  s_waitcnt vmcnt(12)
  v_mfma_f32_32x32x16_bf16 v[80:95], a[40:43], a[116:119], v[80:95]
  v_mfma_f32_32x32x16_bf16 v[96:111], a[44:47], a[112:115], v[96:111]
  s_add_u32 s68, s74, s81
  buffer_load_dwordx4 a[112:115], v4, s[36:39], s68 offen sc1
  v_mfma_f32_32x32x16_bf16 v[112:127], a[44:47], a[116:119], v[112:127]
  buffer_load_dwordx4 a[116:119], v5, s[36:39], s68 offen sc1
  s_waitcnt vmcnt(13)
  v_mfma_f32_32x32x16_bf16 v[64:79], a[48:51], a[120:123], v[64:79]
  s_waitcnt vmcnt(12)
  v_mfma_f32_32x32x16_bf16 v[80:95], a[48:51], a[124:127], v[80:95]
  v_mfma_f32_32x32x16_bf16 v[96:111], a[52:55], a[120:123], v[96:111]
  s_add_u32 s68, s74, s82
  buffer_load_dwordx4 a[120:123], v4, s[36:39], s68 offen sc1
  v_mfma_f32_32x32x16_bf16 v[112:127], a[52:55], a[124:127], v[112:127]
  buffer_load_dwordx4 a[124:127], v5, s[36:39], s68 offen sc1
  s_waitcnt vmcnt(13)
  v_mfma_f32_32x32x16_bf16 v[64:79], a[56:59], v[24:27], v[64:79]
  s_waitcnt vmcnt(12)
  v_mfma_f32_32x32x16_bf16 v[80:95], a[56:59], v[28:31], v[80:95]
  v_mfma_f32_32x32x16_bf16 v[96:111], a[60:63], v[24:27], v[96:111]
  v_mfma_f32_32x32x16_bf16 v[112:127], a[60:63], v[28:31], v[112:127]
  s_waitcnt vmcnt(11)
  v_mfma_f32_32x32x16_bf16 v[64:79], a[64:67], v[32:35], v[64:79]
  s_waitcnt vmcnt(10)
  v_mfma_f32_32x32x16_bf16 v[80:95], a[64:67], v[36:39], v[80:95]
  v_mfma_f32_32x32x16_bf16 v[96:111], a[68:71], v[32:35], v[96:111]
  v_mfma_f32_32x32x16_bf16 v[112:127], a[68:71], v[36:39], v[112:127]
  s_waitcnt vmcnt(9)
  v_mfma_f32_32x32x16_bf16 v[64:79], a[72:75], v[40:43], v[64:79]
  s_waitcnt vmcnt(8)
  v_mfma_f32_32x32x16_bf16 v[80:95], a[72:75], v[44:47], v[80:95]
  v_mfma_f32_32x32x16_bf16 v[96:111], a[76:79], v[40:43], v[96:111]
  v_mfma_f32_32x32x16_bf16 v[112:127], a[76:79], v[44:47], v[112:127]
  s_waitcnt vmcnt(7)
  v_mfma_f32_32x32x16_bf16 v[64:79], a[80:83], v[48:51], v[64:79]
  s_waitcnt vmcnt(6)
  v_mfma_f32_32x32x16_bf16 v[80:95], a[80:83], v[52:55], v[80:95]
  v_mfma_f32_32x32x16_bf16 v[96:111], a[84:87], v[48:51], v[96:111]
  v_mfma_f32_32x32x16_bf16 v[112:127], a[84:87], v[52:55], v[112:127]
  s_waitcnt vmcnt(5)
  v_mfma_f32_32x32x16_bf16 v[64:79], a[88:91], v[56:59], v[64:79]
  s_waitcnt vmcnt(4)
  v_mfma_f32_32x32x16_bf16 v[80:95], a[88:91], v[60:63], v[80:95]
  v_mfma_f32_32x32x16_bf16 v[96:111], a[92:95], v[56:59], v[96:111]
  v_mfma_f32_32x32x16_bf16 v[112:127], a[92:95], v[60:63], v[112:127]
  s_waitcnt vmcnt(3)
  v_mfma_f32_32x32x16_bf16 v[64:79], a[96:99], a[112:115], v[64:79]
  s_waitcnt vmcnt(2)
  v_mfma_f32_32x32x16_bf16 v[80:95], a[96:99], a[116:119], v[80:95]
  v_mfma_f32_32x32x16_bf16 v[96:111], a[100:103], a[112:115], v[96:111]
  v_mfma_f32_32x32x16_bf16 v[112:127], a[100:103], a[116:119], v[112:127]
  s_waitcnt vmcnt(1)
  v_mfma_f32_32x32x16_bf16 v[64:79], a[104:107], a[120:123], v[64:79]
  s_waitcnt vmcnt(0)
  v_mfma_f32_32x32x16_bf16 v[80:95], a[104:107], a[124:127], v[80:95]
  v_mfma_f32_32x32x16_bf16 v[96:111], a[108:111], a[120:123], v[96:111]
  v_mfma_f32_32x32x16_bf16 v[112:127], a[108:111], a[124:127], v[112:127]
  v_mov_b32 v24, v12
  v_mov_b32 v25, v12
  v_mov_b32 v26, v13
  v_mov_b32 v27, v13
  s_nop 3
  v_pk_mul_f32 v[64:65], v[64:65], v[24:25]
  v_pk_mul_f32 v[66:67], v[66:67], v[24:25]
  v_pk_mul_f32 v[68:69], v[68:69], v[24:25]
  v_pk_mul_f32 v[70:71], v[70:71], v[24:25]
  v_pk_mul_f32 v[72:73], v[72:73], v[24:25]
  v_pk_mul_f32 v[74:75], v[74:75], v[24:25]
  v_pk_mul_f32 v[76:77], v[76:77], v[24:25]
  v_pk_mul_f32 v[78:79], v[78:79], v[24:25]
  ds_write_b128 v16, v[64:67] offset:0
  ds_write_b128 v17, v[68:71] offset:0
  ds_write_b128 v18, v[72:75] offset:0
  ds_write_b128 v19, v[76:79] offset:0
  v_pk_mul_f32 v[80:81], v[80:81], v[26:27]
  v_pk_mul_f32 v[82:83], v[82:83], v[26:27]
  v_pk_mul_f32 v[84:85], v[84:85], v[26:27]
  v_pk_mul_f32 v[86:87], v[86:87], v[26:27]
  v_pk_mul_f32 v[88:89], v[88:89], v[26:27]
  v_pk_mul_f32 v[90:91], v[90:91], v[26:27]
  v_pk_mul_f32 v[92:93], v[92:93], v[26:27]
  v_pk_mul_f32 v[94:95], v[94:95], v[26:27]
  ds_write_b128 v16, v[80:83] offset:8192
  ds_write_b128 v17, v[84:87] offset:8192
  ds_write_b128 v18, v[88:91] offset:8192
  ds_write_b128 v19, v[92:95] offset:8192
  v_pk_mul_f32 v[96:97], v[96:97], v[24:25]
  v_pk_mul_f32 v[98:99], v[98:99], v[24:25]
  v_pk_mul_f32 v[100:101], v[100:101], v[24:25]
  v_pk_mul_f32 v[102:103], v[102:103], v[24:25]
  v_pk_mul_f32 v[104:105], v[104:105], v[24:25]
  v_pk_mul_f32 v[106:107], v[106:107], v[24:25]
  v_pk_mul_f32 v[108:109], v[108:109], v[24:25]
  v_pk_mul_f32 v[110:111], v[110:111], v[24:25]
  ds_write_b128 v16, v[96:99] offset:128
  ds_write_b128 v17, v[100:103] offset:128
  ds_write_b128 v18, v[104:107] offset:128
  ds_write_b128 v19, v[108:111] offset:128
  v_pk_mul_f32 v[112:113], v[112:113], v[26:27]
  v_pk_mul_f32 v[114:115], v[114:115], v[26:27]
  v_pk_mul_f32 v[116:117], v[116:117], v[26:27]
  v_pk_mul_f32 v[118:119], v[118:119], v[26:27]
  v_pk_mul_f32 v[120:121], v[120:121], v[26:27]
  v_pk_mul_f32 v[122:123], v[122:123], v[26:27]
  v_pk_mul_f32 v[124:125], v[124:125], v[26:27]
  v_pk_mul_f32 v[126:127], v[126:127], v[26:27]
  ds_write_b128 v16, v[112:115] offset:8320
  ds_write_b128 v17, v[116:119] offset:8320
  ds_write_b128 v18, v[120:123] offset:8320
  ds_write_b128 v19, v[124:127] offset:8320
  s_waitcnt lgkmcnt(0)
  s_barrier
L_k1_end:
  s_endpgm
L_code_end:
  s_endpgm
.section .rodata,"a"
.p2align 6
.amdhsa_kernel gated_mix__ssm_conv_s5__dense_activation_silu__prompt_kernel
  .amdhsa_next_free_vgpr 256
  .amdhsa_next_free_sgpr 102
  .amdhsa_accum_offset 128
  .amdhsa_group_segment_fixed_size 0
  .amdhsa_kernarg_size 128
  .amdhsa_user_sgpr_count 2
  .amdhsa_user_sgpr_kernarg_segment_ptr 1
  .amdhsa_system_sgpr_workgroup_id_x 1
  .amdhsa_float_denorm_mode_32 3
.end_amdhsa_kernel
```
